```python
import torch

def _softmax(x, axis=-1):
    return torch.softmax(x, dim=axis)

def _gelu(x):
    return torch.nn.functional.gelu(x, approximate='tanh')

def _silu(x):
    return torch.nn.functional.silu(x)

def _sigmoid(x):
    return torch.sigmoid(x)

def _layernorm(x, axis=-1, eps=1e-05):
    m = x.mean(dim=axis, keepdim=True)
    v = x.var(dim=axis, keepdim=True, unbiased=False)
    return (x - m) / torch.sqrt(v + eps)

def _scatter_add(tgt, idx, src, axis=0):
    return tgt.clone().index_add_(axis, idx, src)

def _segment_sum(src, seg, n):
    out = torch.zeros((n,) + src.shape[1:], dtype=src.dtype)
    return out.index_add_(0, seg, src)

def _pad(x, pw):
    flat = tuple((v for pair in reversed(pw) for v in pair))
    return torch.nn.functional.pad(x, flat)
kernel_name = 'gather_scatter__tensor_product_equiv_equiformer__graph'

def setup_inputs():

    _w = lambda a: (lambda t: t.to(torch.bfloat16) if t.is_floating_point() else t)(torch.as_tensor(a))
    N, deg, C, De = (12500, 64, 64, max(16, 1))
    E = N * deg
    src = (lambda lo, hi, *s: torch.randint(lo, hi, s))(0, N, E).to(torch.int64)
    dst = (lambda lo, hi, *s: torch.randint(lo, hi, s))(0, N, E).to(torch.int64)
    rvec = (lambda *s: torch.randn(*s, dtype=torch.bfloat16) * 0.05)(E, 3).to(float)
    rn = (torch.linalg.norm(rvec, dim=-1, keepdim=True) + 1e-06).to(float)
    rhat = (rvec / rn).to(float)
    eps = torch.zeros((3, 3, 3), dtype=float)
    eps[0, 1, 2] = eps[1, 2, 0] = eps[2, 0, 1] = 1.0
    eps[0, 2, 1] = eps[2, 1, 0] = eps[1, 0, 2] = -1.0
    return {'x': _w((lambda *s: torch.randn(*s, dtype=torch.bfloat16) * 0.2)(N, 4 * C).to(float)), 'rhat': _w(rhat), 'e_attr': _w((lambda *s: torch.randn(*s, dtype=torch.bfloat16) * 0.2)(E, De).to(float)), 'src': _w(src), 'dst': _w(dst), 'w_rad': _w((lambda *s: torch.randn(*s, dtype=torch.bfloat16) * 0.2)(De, 5 * C).to(float)), 'w_si0': _w((lambda *s: torch.randn(*s, dtype=torch.bfloat16) * 0.2)(2 * C, C).to(float)), 'w_si1': _w((lambda *s: torch.randn(*s, dtype=torch.bfloat16) * 0.05)(3 * C, C).to(float)), 'cg_eps': _w(eps)}

def reference(x, rhat, e_attr, src, dst, w_rad, w_si0, w_si1, cg_eps):
    N = x.shape[0]
    C = w_si0.shape[1]
    E = rhat.shape[0]
    x0 = x[:, :C].clone()
    x1 = x[:, C:].reshape(N, 3, C)
    R = (e_attr @ w_rad).reshape(E, 5, C)
    f0 = x0[src]
    f1 = x1[src]
    Y1 = rhat
    p00_0 = f0 * R[:, 0, :]
    p11_0 = torch.einsum('ejc,ej->ec', f1, Y1) * R[:, 1, :]
    p01_1 = torch.einsum('ec,ej->ejc', f0, Y1) * R[:, 2, :][:, None, :]
    p10_1 = f1 * R[:, 3, :][:, None, :]
    p11_1 = torch.einsum('ijk,ekc,ej->eic', cg_eps, f1, Y1) * R[:, 4, :][:, None, :]
    m0 = torch.concatenate([p00_0, p11_0], axis=-1) @ w_si0
    m1 = torch.einsum('ejp,pc->ejc', torch.concatenate([p01_1, p10_1, p11_1], axis=-1), w_si1)
    agg0 = _segment_sum(m0, dst, N)
    agg1 = _segment_sum(m1.reshape(E, 3 * C), dst, N).reshape(N, 3, C)
    gate = _sigmoid(agg0)
    out1 = agg1 * gate[:, None, :]
    return torch.concatenate([agg0, out1.reshape(N, 3 * C)], axis=-1)
```

```asm
; @launch kernel=gather_scatter__tensor_product_equiv_equiformer__graph_kernel grid=(256,1,1) block=(512,1,1) lds=163840
.amdgcn_target "amdgcn-amd-amdhsa--gfx950"
.text
.globl gather_scatter__tensor_product_equiv_equiformer__graph_kernel
.p2align 8
.type gather_scatter__tensor_product_equiv_equiformer__graph_kernel,@function
gather_scatter__tensor_product_equiv_equiformer__graph_kernel:
    s_cmp_ge_u32 s2, 256
    s_cbranch_scc1 K2_end
    s_and_b32 s3, s2, 7
    s_lshl_b32 s3, s3, 5
    s_lshr_b32 s2, s2, 3
    s_or_b32 s2, s2, s3
    v_mov_b32 v250, v0
    s_mov_b32 s38, 0
    s_mov_b32 s40, 3392
    s_load_dwordx8 s[4:11], s[0:1], 0
    s_load_dwordx8 s[52:59], s[0:1], 32
    s_load_dwordx4 s[12:15], s[0:1], 80
    v_lshlrev_b32 v1, 4, v0
    v_mul_u32_u24 v2, 24, v0
    v_and_b32 v3, 63, v0
    v_lshlrev_b32 v3, 4, v3
    v_lshrrev_b32 v72, 6, v0
    s_nop 0
    v_readfirstlane_b32 s3, v72
    s_mul_i32 s60, s2, 12800
    s_mul_i32 s61, s2, 19200
    s_mul_i32 s62, s2, 25600
    s_mul_i32 s63, s2, 102400
    s_mul_i32 s64, s2, 38400
    s_lshl_b32 s65, s2, 10
    s_mov_b32 s66, 8192
    s_waitcnt lgkmcnt(0)
    s_add_u32 s76, s12, 0
    s_addc_u32 s77, s13, 0
    s_mov_b32 s78, 256
    s_mov_b32 s79, 0x20000
    s_add_u32 s84, s14, 393216
    s_addc_u32 s85, s15, 0
    s_mov_b32 s86, 32768
    s_mov_b32 s87, 0x20000
    v_and_b32 v251, 63, v0
    s_or_b32 s74, s2, s3
    s_cbranch_scc1 P1_notag
    s_memrealtime s[74:75]
    s_waitcnt lgkmcnt(0)
    s_or_b32 s74, s74, 1
    v_mov_b32 v110, s74
    v_mov_b32 v111, 0
    s_mov_b64 exec, 1
    buffer_store_dword v110, v111, s[76:79], 0 offen sc1
    s_mov_b64 exec, -1
P1_notag:
    s_mov_b32 s96, 0
    s_cmp_ge_u32 s2, 250
    s_cbranch_scc1 P1_prep
    s_add_u32 s16, s52, s60
    s_addc_u32 s17, s53, 0
    s_mov_b32 s18, 12800
    s_mov_b32 s19, 0x20000
    buffer_load_dwordx4 v[4:7], v1, s[16:19], 0 offen nt
    buffer_load_dwordx4 v[8:11], v1, s[16:19], s66 offen nt
    v_lshlrev_b32 v73, 2, v0
    v_mov_b32 v74, 0
    s_cmp_ge_u32 s3, 4
    s_cbranch_scc1 P1_nozero
    v_add_u32 v73, 147200, v73
    ds_write_b32 v73, v74
P1_nozero:
    s_add_u32 s20, s10, s60
    s_addc_u32 s21, s11, 0
    s_mov_b32 s22, 12800
    s_mov_b32 s23, 0x20000
    s_add_u32 s24, s6, s61
    s_addc_u32 s25, s7, 0
    s_mov_b32 s26, 19200
    s_mov_b32 s27, 0x20000
    s_add_u32 s28, s4, s62
    s_addc_u32 s29, s5, 0
    s_mov_b32 s30, 25600
    s_mov_b32 s31, 0x20000
    s_add_u32 s32, s8, s63
    s_addc_u32 s33, s9, 0
    s_mov_b32 s34, 102400
    s_mov_b32 s35, 0x20000
    s_mov_b32 s69, 12288
    s_lshl_b32 s67, s3, 10
    s_waitcnt lgkmcnt(0)
    s_barrier
    buffer_load_dwordx4 v[12:15], v1, s[20:23], 0 offen nt
    buffer_load_dwordx4 v[16:19], v1, s[20:23], s66 offen nt
    buffer_load_dwordx4 v[20:23], v2, s[24:27], 0 offen nt
    buffer_load_dwordx2 v[24:25], v2, s[24:27], 0 offen offset:16 nt
    buffer_load_dwordx4 v[26:29], v2, s[24:27], s69 offen nt
    buffer_load_dwordx2 v[30:31], v2, s[24:27], s69 offen offset:16 nt
    s_mov_b32 s68, 0
    buffer_load_dwordx4 v[32:35], v1, s[28:31], s68 offen nt
    s_add_u32 s68, s68, 8192
    buffer_load_dwordx4 v[36:39], v1, s[28:31], s68 offen nt
    s_add_u32 s68, s68, 8192
    buffer_load_dwordx4 v[40:43], v1, s[28:31], s68 offen nt
    s_add_u32 s68, s68, 8192
    buffer_load_dwordx4 v[44:47], v1, s[28:31], s68 offen nt
    s_add_u32 s68, s68, 8192
    s_mov_b32 m0, s67
    s_nop 0
    buffer_load_dwordx4 v3, s[32:35], s67 offen nt lds
    s_add_u32 s67, s67, 8192
    s_mov_b32 m0, s67
    s_nop 0
    buffer_load_dwordx4 v3, s[32:35], s67 offen nt lds
    s_add_u32 s67, s67, 8192
    s_mov_b32 m0, s67
    s_nop 0
    buffer_load_dwordx4 v3, s[32:35], s67 offen nt lds
    s_add_u32 s67, s67, 8192
    s_mov_b32 m0, s67
    s_nop 0
    buffer_load_dwordx4 v3, s[32:35], s67 offen nt lds
    s_add_u32 s67, s67, 8192
    s_mov_b32 m0, s67
    s_nop 0
    buffer_load_dwordx4 v3, s[32:35], s67 offen nt lds
    s_add_u32 s67, s67, 8192
    s_mov_b32 m0, s67
    s_nop 0
    buffer_load_dwordx4 v3, s[32:35], s67 offen nt lds
    s_add_u32 s67, s67, 8192
    s_mov_b32 m0, s67
    s_nop 0
    buffer_load_dwordx4 v3, s[32:35], s67 offen nt lds
    s_add_u32 s67, s67, 8192
    s_mov_b32 m0, s67
    s_nop 0
    buffer_load_dwordx4 v3, s[32:35], s67 offen nt lds
    s_add_u32 s67, s67, 8192
    s_mov_b32 m0, s67
    s_nop 0
    buffer_load_dwordx4 v3, s[32:35], s67 offen nt lds
    s_add_u32 s67, s67, 8192
    s_mov_b32 m0, s67
    s_nop 0
    buffer_load_dwordx4 v3, s[32:35], s67 offen nt lds
    s_add_u32 s67, s67, 8192
    s_mov_b32 m0, s67
    s_nop 0
    buffer_load_dwordx4 v3, s[32:35], s67 offen nt lds
    s_add_u32 s67, s67, 8192
    s_mov_b32 m0, s67
    s_nop 0
    buffer_load_dwordx4 v3, s[32:35], s67 offen nt lds
    s_add_u32 s67, s67, 8192
    s_cmp_ge_u32 s3, 4
    s_cbranch_scc1 P1_noe13
    s_mov_b32 m0, s67
    s_nop 0
    buffer_load_dwordx4 v3, s[32:35], s67 offen nt lds
    s_add_u32 s67, s67, 8192
P1_noe13:
    s_add_u32 s68, s64, 1048576
    s_add_u32 s36, s14, s68
    s_addc_u32 s37, s15, 0
    s_mov_b32 s38, 38400
    s_mov_b32 s39, 0x20000
    s_add_u32 s68, s63, 18874368
    s_add_u32 s40, s14, s68
    s_addc_u32 s41, s15, 0
    s_mov_b32 s42, 102400
    s_mov_b32 s43, 0x20000
    s_add_u32 s44, s14, 11534336
    s_addc_u32 s45, s15, 0
    s_mov_b32 s46, 6400000
    s_mov_b32 s47, 0x20000
    s_add_u32 s48, s14, s65
    s_addc_u32 s49, s15, 0
    s_mov_b32 s50, 1024
    s_mov_b32 s51, 0x20000
    v_cmp_gt_u32 vcc, 288, v0
    s_nop 0
    s_mov_b64 s[70:71], vcc
    v_mov_b32 v75, 1
    s_waitcnt vmcnt(22)
    v_mul_u32_u24 v48, 21400, v4
    v_lshrrev_b32 v48, 20, v48
    v_mul_u32_u24 v64, 49, v48
    v_sub_u32 v64, v4, v64
    v_lshlrev_b32 v48, 2, v48
    v_add_u32 v48, 147200, v48
    ds_add_rtn_u32 v56, v48, v75
    v_mul_u32_u24 v49, 21400, v5
    v_lshrrev_b32 v49, 20, v49
    v_mul_u32_u24 v65, 49, v49
    v_sub_u32 v65, v5, v65
    v_lshlrev_b32 v49, 2, v49
    v_add_u32 v49, 147200, v49
    ds_add_rtn_u32 v57, v49, v75
    v_mul_u32_u24 v50, 21400, v6
    v_lshrrev_b32 v50, 20, v50
    v_mul_u32_u24 v66, 49, v50
    v_sub_u32 v66, v6, v66
    v_lshlrev_b32 v50, 2, v50
    v_add_u32 v50, 147200, v50
    ds_add_rtn_u32 v58, v50, v75
    v_mul_u32_u24 v51, 21400, v7
    v_lshrrev_b32 v51, 20, v51
    v_mul_u32_u24 v67, 49, v51
    v_sub_u32 v67, v7, v67
    v_lshlrev_b32 v51, 2, v51
    v_add_u32 v51, 147200, v51
    ds_add_rtn_u32 v59, v51, v75
    s_mov_b64 exec, s[70:71]
    s_cbranch_execz P1_skip_rank
    v_mul_u32_u24 v52, 21400, v8
    v_lshrrev_b32 v52, 20, v52
    v_mul_u32_u24 v68, 49, v52
    v_sub_u32 v68, v8, v68
    v_lshlrev_b32 v52, 2, v52
    v_add_u32 v52, 147200, v52
    ds_add_rtn_u32 v60, v52, v75
    v_mul_u32_u24 v53, 21400, v9
    v_lshrrev_b32 v53, 20, v53
    v_mul_u32_u24 v69, 49, v53
    v_sub_u32 v69, v9, v69
    v_lshlrev_b32 v53, 2, v53
    v_add_u32 v53, 147200, v53
    ds_add_rtn_u32 v61, v53, v75
    v_mul_u32_u24 v54, 21400, v10
    v_lshrrev_b32 v54, 20, v54
    v_mul_u32_u24 v70, 49, v54
    v_sub_u32 v70, v10, v70
    v_lshlrev_b32 v54, 2, v54
    v_add_u32 v54, 147200, v54
    ds_add_rtn_u32 v62, v54, v75
    v_mul_u32_u24 v55, 21400, v11
    v_lshrrev_b32 v55, 20, v55
    v_mul_u32_u24 v71, 49, v55
    v_sub_u32 v71, v11, v71
    v_lshlrev_b32 v55, 2, v55
    v_add_u32 v55, 147200, v55
    ds_add_rtn_u32 v63, v55, v75
P1_skip_rank:
    s_mov_b64 exec, -1
    s_waitcnt lgkmcnt(0)
    s_barrier
    s_cmp_lg_u32 s3, 0
    s_cbranch_scc1 P1_noscan
    v_add_u32 v73, 147200, v3
    ds_read_b128 v[76:79], v73
    s_waitcnt lgkmcnt(0)
    v_add_u32 v81, v76, v77
    v_add_u32 v82, v81, v78
    v_add_u32 v83, v82, v79
    v_mov_b32 v84, v83
    s_nop 1
    v_add_u32_dpp v84, v84, v84 row_shr:1 row_mask:0xf bank_mask:0xf bound_ctrl:1
    s_nop 1
    v_add_u32_dpp v84, v84, v84 row_shr:2 row_mask:0xf bank_mask:0xf bound_ctrl:1
    s_nop 1
    v_add_u32_dpp v84, v84, v84 row_shr:4 row_mask:0xf bank_mask:0xf bound_ctrl:1
    s_nop 1
    v_add_u32_dpp v84, v84, v84 row_shr:8 row_mask:0xf bank_mask:0xf bound_ctrl:1
    s_nop 1
    v_add_u32_dpp v84, v84, v84 row_bcast:15 row_mask:0xa bank_mask:0xf
    s_nop 1
    v_add_u32_dpp v84, v84, v84 row_bcast:31 row_mask:0xc bank_mask:0xf
    v_sub_u32 v84, v84, v83
    v_add_u32 v85, v84, v76
    v_add_u32 v86, v84, v81
    v_add_u32 v87, v84, v82
    ds_write_b128 v73, v[84:87]
    v_lshl_or_b32 v88, v76, 16, v84
    v_lshl_or_b32 v89, v77, 16, v85
    v_lshl_or_b32 v90, v78, 16, v86
    v_lshl_or_b32 v91, v79, 16, v87
    buffer_store_dwordx4 v[88:91], v3, s[48:51], 0 offen sc1
    s_waitcnt lgkmcnt(0)
P1_noscan:
    v_lshrrev_b32 v92, 5, v0
    s_mul_i32 s69, s2, 50
    v_add_u32 v92, s69, v92
    v_lshlrev_b32 v92, 8, v92
    v_bfe_u32 v93, v0, 3, 2
    v_lshl_add_u32 v92, v93, 6, v92
    v_and_b32 v93, 3, v0
    v_lshl_add_u32 v92, v93, 4, v92
    v_bfe_u32 v93, v0, 2, 1
    v_mul_u32_u24 v93, 3200000, v93
    v_add_u32 v92, v92, v93
    v_cmp_gt_u32 vcc, 64, v0
    v_mov_b32 v94, 0x80000000
    s_nop 0
    v_cndmask_b32 v93, v94, v92, vcc
    s_mov_b32 s72, 0x80000000
    s_mov_b32 s73, 0xffff0000
    v_lshlrev_b32 v95, 2, v0
    s_barrier
    ds_read_b32 v48, v48
    ds_read_b32 v49, v49
    ds_read_b32 v50, v50
    ds_read_b32 v51, v51
    s_waitcnt vmcnt(16)
    v_lshl_or_b32 v12, v12, 8, v64
    v_or_b32 v12, s72, v12
    v_lshl_or_b32 v13, v13, 8, v65
    v_or_b32 v13, s72, v13
    v_lshl_or_b32 v14, v14, 8, v66
    v_or_b32 v14, s72, v14
    v_lshl_or_b32 v15, v15, 8, v67
    v_or_b32 v15, s72, v15
    v_lshlrev_b32 v76, 16, v21
    v_alignbit_b32 v77, v22, v21, 16
    v_and_b32 v78, s73, v22
    v_lshlrev_b32 v79, 16, v24
    v_alignbit_b32 v80, v25, v24, 16
    v_and_b32 v81, s73, v25
    s_waitcnt lgkmcnt(0)
    v_add_u32 v56, v56, v48
    v_mul_u32_u24 v48, 12, v56
    v_add_u32 v48, 102400, v48
    ds_write2_b32 v48, v12, v20 offset0:0 offset1:1
    ds_write_b32 v48, v76 offset:8
    v_lshlrev_b32 v56, 1, v56
    v_add_u32 v56, 140800, v56
    v_add_u32 v82, 0, v95
    ds_write_b16 v56, v82
    v_add_u32 v57, v57, v49
    v_mul_u32_u24 v49, 12, v57
    v_add_u32 v49, 102400, v49
    ds_write2_b32 v49, v13, v77 offset0:0 offset1:1
    ds_write_b32 v49, v78 offset:8
    v_lshlrev_b32 v57, 1, v57
    v_add_u32 v57, 140800, v57
    v_add_u32 v83, 1, v95
    ds_write_b16 v57, v83
    v_add_u32 v58, v58, v50
    v_mul_u32_u24 v50, 12, v58
    v_add_u32 v50, 102400, v50
    ds_write2_b32 v50, v14, v23 offset0:0 offset1:1
    ds_write_b32 v50, v79 offset:8
    v_lshlrev_b32 v58, 1, v58
    v_add_u32 v58, 140800, v58
    v_add_u32 v84, 2, v95
    ds_write_b16 v58, v84
    v_add_u32 v59, v59, v51
    v_mul_u32_u24 v51, 12, v59
    v_add_u32 v51, 102400, v51
    ds_write2_b32 v51, v15, v80 offset0:0 offset1:1
    ds_write_b32 v51, v81 offset:8
    v_lshlrev_b32 v59, 1, v59
    v_add_u32 v59, 140800, v59
    v_add_u32 v85, 3, v95
    ds_write_b16 v59, v85
    s_mov_b64 exec, s[70:71]
    s_cbranch_execz P1_skip_scatter
    ds_read_b32 v52, v52
    ds_read_b32 v53, v53
    ds_read_b32 v54, v54
    ds_read_b32 v55, v55
    v_lshl_or_b32 v16, v16, 8, v68
    v_or_b32 v16, s72, v16
    v_lshl_or_b32 v17, v17, 8, v69
    v_or_b32 v17, s72, v17
    v_lshl_or_b32 v18, v18, 8, v70
    v_or_b32 v18, s72, v18
    v_lshl_or_b32 v19, v19, 8, v71
    v_or_b32 v19, s72, v19
    v_lshlrev_b32 v76, 16, v27
    v_alignbit_b32 v77, v28, v27, 16
    v_and_b32 v78, s73, v28
    v_lshlrev_b32 v79, 16, v30
    v_alignbit_b32 v80, v31, v30, 16
    v_and_b32 v81, s73, v31
    s_waitcnt lgkmcnt(0)
    v_add_u32 v60, v60, v52
    v_mul_u32_u24 v52, 12, v60
    v_add_u32 v52, 102400, v52
    ds_write2_b32 v52, v16, v26 offset0:0 offset1:1
    ds_write_b32 v52, v76 offset:8
    v_lshlrev_b32 v60, 1, v60
    v_add_u32 v60, 140800, v60
    v_add_u32 v82, 2048, v95
    ds_write_b16 v60, v82
    v_add_u32 v61, v61, v53
    v_mul_u32_u24 v53, 12, v61
    v_add_u32 v53, 102400, v53
    ds_write2_b32 v53, v17, v77 offset0:0 offset1:1
    ds_write_b32 v53, v78 offset:8
    v_lshlrev_b32 v61, 1, v61
    v_add_u32 v61, 140800, v61
    v_add_u32 v83, 2049, v95
    ds_write_b16 v61, v83
    v_add_u32 v62, v62, v54
    v_mul_u32_u24 v54, 12, v62
    v_add_u32 v54, 102400, v54
    ds_write2_b32 v54, v18, v29 offset0:0 offset1:1
    ds_write_b32 v54, v79 offset:8
    v_lshlrev_b32 v62, 1, v62
    v_add_u32 v62, 140800, v62
    v_add_u32 v84, 2050, v95
    ds_write_b16 v62, v84
    v_add_u32 v63, v63, v55
    v_mul_u32_u24 v55, 12, v63
    v_add_u32 v55, 102400, v55
    ds_write2_b32 v55, v19, v80 offset0:0 offset1:1
    ds_write_b32 v55, v81 offset:8
    v_lshlrev_b32 v63, 1, v63
    v_add_u32 v63, 140800, v63
    v_add_u32 v85, 2051, v95
    ds_write_b16 v63, v85
P1_skip_scatter:
    s_mov_b64 exec, -1
    s_waitcnt vmcnt(12)
    s_mov_b32 s68, 0
    buffer_store_dwordx4 v[32:35], v92, s[44:47], s68 offen sc1
    s_add_u32 s68, s68, 4096
    buffer_store_dwordx4 v[36:39], v92, s[44:47], s68 offen sc1
    s_add_u32 s68, s68, 4096
    buffer_store_dwordx4 v[40:43], v92, s[44:47], s68 offen sc1
    s_add_u32 s68, s68, 4096
    buffer_store_dwordx4 v[44:47], v93, s[44:47], s68 offen sc1
    s_add_u32 s68, s68, 4096
    s_waitcnt lgkmcnt(0)
    s_barrier
    v_add_u32 v73, 102400, v1
    ds_read_b128 v[4:7], v73 offset:0
    ds_read_b128 v[8:11], v73 offset:8192
    ds_read_b128 v[12:15], v73 offset:16384
    ds_read_b128 v[16:19], v73 offset:24576
    ds_read_b128 v[20:23], v73 offset:32768
    v_and_b32 v74, 0x1fe, v0
    v_add_u32 v74, 140800, v74
    s_mov_b32 s68, 0
    s_waitcnt lgkmcnt(4)
    buffer_store_dwordx4 v[4:7], v1, s[36:39], s68 offen sc1
    s_add_u32 s68, s68, 8192
    s_waitcnt lgkmcnt(3)
    buffer_store_dwordx4 v[8:11], v1, s[36:39], s68 offen sc1
    s_add_u32 s68, s68, 8192
    s_waitcnt lgkmcnt(2)
    buffer_store_dwordx4 v[12:15], v1, s[36:39], s68 offen sc1
    s_add_u32 s68, s68, 8192
    s_waitcnt lgkmcnt(1)
    buffer_store_dwordx4 v[16:19], v1, s[36:39], s68 offen sc1
    s_add_u32 s68, s68, 8192
    s_waitcnt lgkmcnt(0)
    buffer_store_dwordx4 v[20:23], v1, s[36:39], s68 offen sc1
    s_add_u32 s68, s68, 8192
    ds_read_u16 v48, v74 offset:0
    ds_read_u16 v49, v74 offset:512
    ds_read_u16 v50, v74 offset:1024
    ds_read_u16 v51, v74 offset:1536
    ds_read_u16 v52, v74 offset:2048
    ds_read_u16 v53, v74 offset:2560
    ds_read_u16 v54, v74 offset:3072
    ds_read_u16 v55, v74 offset:3584
    ds_read_u16 v56, v74 offset:4096
    ds_read_u16 v57, v74 offset:4608
    ds_read_u16 v58, v74 offset:5120
    ds_read_u16 v59, v74 offset:5632
    ds_read_u16 v60, v74 offset:6144
    v_mov_b32 v111, 0
    buffer_load_dword v110, v111, s[76:79], 0 offen sc1
    v_and_b32 v75, 1, v0
    v_lshlrev_b32 v75, 4, v75
    s_waitcnt lgkmcnt(0)
    v_lshl_add_u32 v48, v48, 5, v75
    v_lshl_add_u32 v49, v49, 5, v75
    v_lshl_add_u32 v50, v50, 5, v75
    v_lshl_add_u32 v51, v51, 5, v75
    v_lshl_add_u32 v52, v52, 5, v75
    v_lshl_add_u32 v53, v53, 5, v75
    v_lshl_add_u32 v54, v54, 5, v75
    v_lshl_add_u32 v55, v55, 5, v75
    v_lshl_add_u32 v56, v56, 5, v75
    v_lshl_add_u32 v57, v57, 5, v75
    v_lshl_add_u32 v58, v58, 5, v75
    v_lshl_add_u32 v59, v59, 5, v75
    v_lshl_add_u32 v60, v60, 5, v75
    s_waitcnt vmcnt(0)
    v_readfirstlane_b32 s96, v110
    s_barrier
    s_cmp_lg_u32 s3, 7
    s_cbranch_scc1 P1_sa
    s_cmp_lg_u32 s96, 0
    s_cbranch_scc1 P1_sa_n_d
    s_mov_b32 s62, 0x100000
    v_mov_b32 v111, 0
P1_sa_n_l:
    buffer_load_dword v110, v111, s[76:79], 0 offen sc1
    s_sub_u32 s62, s62, 1
    s_cbranch_scc1 P1_sa_n_d
    s_waitcnt vmcnt(0)
    v_readfirstlane_b32 s96, v110
    s_nop 0
    s_cmp_eq_u32 s96, 0
    s_cbranch_scc1 P1_sa_n_l
P1_sa_n_d:
    v_and_b32 v111, 63, v0
    v_lshlrev_b32 v111, 10, v111
    v_mov_b32 v110, s96
    s_lshl_b32 s62, s2, 2
    s_add_u32 s62, s62, 0
    s_bfm_b64 exec, 16, 0
    buffer_store_dword v110, v111, s[84:87], s62 offen sc1
    s_mov_b64 exec, -1
P1_sa:
    ds_read_b128 v[128:131], v48
    ds_read_b128 v[132:135], v49
    ds_read_b128 v[136:139], v50
    ds_read_b128 v[140:143], v51
    ds_read_b128 v[144:147], v52
    ds_read_b128 v[148:151], v53
    ds_read_b128 v[152:155], v54
    ds_read_b128 v[156:159], v55
    ds_read_b128 v[160:163], v56
    ds_read_b128 v[164:167], v57
    ds_read_b128 v[168:171], v58
    ds_read_b128 v[172:175], v59
    s_mov_b32 s68, 0
    s_waitcnt lgkmcnt(11)
    buffer_store_dwordx4 v[128:131], v1, s[40:43], s68 offen sc1
    s_add_u32 s68, s68, 8192
    s_waitcnt lgkmcnt(10)
    buffer_store_dwordx4 v[132:135], v1, s[40:43], s68 offen sc1
    s_add_u32 s68, s68, 8192
    s_waitcnt lgkmcnt(9)
    buffer_store_dwordx4 v[136:139], v1, s[40:43], s68 offen sc1
    s_add_u32 s68, s68, 8192
    s_waitcnt lgkmcnt(8)
    buffer_store_dwordx4 v[140:143], v1, s[40:43], s68 offen sc1
    s_add_u32 s68, s68, 8192
    s_waitcnt lgkmcnt(7)
    buffer_store_dwordx4 v[144:147], v1, s[40:43], s68 offen sc1
    s_add_u32 s68, s68, 8192
    s_waitcnt lgkmcnt(6)
    buffer_store_dwordx4 v[148:151], v1, s[40:43], s68 offen sc1
    s_add_u32 s68, s68, 8192
    s_waitcnt lgkmcnt(5)
    buffer_store_dwordx4 v[152:155], v1, s[40:43], s68 offen sc1
    s_add_u32 s68, s68, 8192
    s_waitcnt lgkmcnt(4)
    buffer_store_dwordx4 v[156:159], v1, s[40:43], s68 offen sc1
    s_add_u32 s68, s68, 8192
    s_waitcnt lgkmcnt(3)
    buffer_store_dwordx4 v[160:163], v1, s[40:43], s68 offen sc1
    s_add_u32 s68, s68, 8192
    s_waitcnt lgkmcnt(2)
    buffer_store_dwordx4 v[164:167], v1, s[40:43], s68 offen sc1
    s_add_u32 s68, s68, 8192
    s_waitcnt lgkmcnt(1)
    buffer_store_dwordx4 v[168:171], v1, s[40:43], s68 offen sc1
    s_add_u32 s68, s68, 8192
    s_waitcnt lgkmcnt(0)
    buffer_store_dwordx4 v[172:175], v1, s[40:43], s68 offen sc1
    s_add_u32 s68, s68, 8192
    s_cmp_ge_u32 s3, 4
    s_cbranch_scc1 P1_fin
    ds_read_b128 v[176:179], v60
    s_waitcnt lgkmcnt(0)
    buffer_store_dwordx4 v[176:179], v1, s[40:43], s68 offen sc1
    s_branch P1_fin
P1_prep:
    s_getpc_b64 s[36:37]
P1_here:
    s_mov_b32 s38, K2_end-P1_here
    s_mov_b32 s39, 0x20000
    v_lshlrev_b32 v60, 7, v0
    buffer_load_dword v61, v60, s[36:39], 0 offen
    s_cmp_eq_u32 s2, 255
    s_cbranch_scc1 P1_prepd
    s_add_u32 s16, s54, 0
    s_addc_u32 s17, s55, 0
    s_mov_b32 s18, 10240
    s_mov_b32 s19, 0x20000
    s_add_u32 s20, s56, 0
    s_addc_u32 s21, s57, 0
    s_mov_b32 s22, 16384
    s_mov_b32 s23, 0x20000
    s_add_u32 s24, s58, 0
    s_addc_u32 s25, s59, 0
    s_mov_b32 s26, 24576
    s_mov_b32 s27, 0x20000
    s_add_u32 s28, s14, 262144
    s_addc_u32 s29, s15, 0
    s_mov_b32 s30, 20480
    s_mov_b32 s31, 0x20000
    s_add_u32 s32, s14, 294912
    s_addc_u32 s33, s15, 0
    s_mov_b32 s34, 40960
    s_mov_b32 s35, 0x20000
    s_sub_u32 s60, s2, 250
    s_lshl_b32 s60, s60, 10
    v_add_u32 v4, s60, v0
    v_and_b32 v5, 3, v4
    v_bfe_u32 v6, v4, 2, 4
    v_bfe_u32 v7, v4, 6, 2
    v_lshrrev_b32 v8, 8, v4
    v_cmp_le_u32 vcc, 10, v8
    s_nop 1
    v_cndmask_b32 v9, 0, 1, vcc
    v_mul_u32_u24 v10, 10, v9
    v_sub_u32 v10, v8, v10
    v_lshl_add_u32 v11, v7, 2, v5
    v_mul_u32_u24 v11, 320, v11
    v_lshrrev_b32 v12, 1, v10
    v_lshl_add_u32 v11, v12, 6, v11
    v_lshl_add_u32 v11, v9, 5, v11
    v_and_b32 v12, 1, v10
    v_lshl_add_u32 v11, v12, 4, v11
    v_add_u32 v11, v11, v6
    v_lshlrev_b32 v11, 1, v11
    buffer_load_ushort v13, v11, s[16:19], 0 offen
    v_mov_b32 v30, 0x80000000
    v_add_u32 v14, 0, v8
    v_mul_u32_u24 v15, 26, v14
    v_lshrrev_b32 v15, 8, v15
    v_mul_u32_u24 v16, 10, v15
    v_sub_u32 v16, v14, v16
    v_lshrrev_b32 v17, 1, v16
    v_and_b32 v18, 1, v16
    v_lshl_add_u32 v19, v7, 2, v5
    v_lshl_add_u32 v19, v18, 5, v19
    v_lshl_add_u32 v19, v17, 6, v19
    v_lshrrev_b32 v20, 1, v15
    v_and_b32 v21, 1, v15
    v_lshrrev_b32 v22, 2, v6
    v_lshlrev_b32 v22, 3, v22
    v_lshl_add_u32 v22, v20, 5, v22
    v_lshl_add_u32 v22, v21, 2, v22
    v_and_b32 v23, 3, v6
    v_add_u32 v22, v22, v23
    v_lshl_add_u32 v22, v19, 6, v22
    v_lshlrev_b32 v22, 1, v22
    v_subrev_u32 v23, 16384, v22
    v_cmp_gt_u32 vcc, 2, v17
    s_nop 1
    v_cndmask_b32 v24, v30, v22, vcc
    v_cndmask_b32 v25, v23, v30, vcc
    buffer_load_ushort v32, v24, s[20:23], 0 offen
    buffer_load_ushort v33, v24, s[20:23], 0 offen offset:2048
    buffer_load_ushort v34, v25, s[24:27], 0 offen
    buffer_load_ushort v35, v25, s[24:27], 0 offen offset:2048
    v_add_u32 v14, 20, v8
    v_mul_u32_u24 v15, 26, v14
    v_lshrrev_b32 v15, 8, v15
    v_mul_u32_u24 v16, 10, v15
    v_sub_u32 v16, v14, v16
    v_lshrrev_b32 v17, 1, v16
    v_and_b32 v18, 1, v16
    v_lshl_add_u32 v19, v7, 2, v5
    v_lshl_add_u32 v19, v18, 5, v19
    v_lshl_add_u32 v19, v17, 6, v19
    v_lshrrev_b32 v20, 1, v15
    v_and_b32 v21, 1, v15
    v_lshrrev_b32 v22, 2, v6
    v_lshlrev_b32 v22, 3, v22
    v_lshl_add_u32 v22, v20, 5, v22
    v_lshl_add_u32 v22, v21, 2, v22
    v_and_b32 v23, 3, v6
    v_add_u32 v22, v22, v23
    v_lshl_add_u32 v22, v19, 6, v22
    v_lshlrev_b32 v22, 1, v22
    v_subrev_u32 v23, 16384, v22
    v_cmp_gt_u32 vcc, 2, v17
    s_nop 1
    v_cndmask_b32 v24, v30, v22, vcc
    v_cndmask_b32 v25, v23, v30, vcc
    buffer_load_ushort v40, v24, s[20:23], 0 offen
    buffer_load_ushort v41, v24, s[20:23], 0 offen offset:2048
    buffer_load_ushort v42, v25, s[24:27], 0 offen
    buffer_load_ushort v43, v25, s[24:27], 0 offen offset:2048
    v_lshlrev_b32 v4, 2, v4
    s_mov_b32 s61, 20480
    s_waitcnt vmcnt(0)
    v_lshlrev_b32 v13, 16, v13
    buffer_store_dword v13, v4, s[28:31], 0 offen sc1
    v_or_b32 v32, v32, v34
    v_or_b32 v33, v33, v35
    v_lshl_or_b32 v32, v33, 16, v32
    buffer_store_dword v32, v4, s[32:35], 0 offen sc1
    v_or_b32 v40, v40, v42
    v_or_b32 v41, v41, v43
    v_lshl_or_b32 v40, v41, 16, v40
    buffer_store_dword v40, v4, s[32:35], s61 offen sc1
    s_add_u32 s60, s60, 512
    v_add_u32 v4, s60, v0
    v_and_b32 v5, 3, v4
    v_bfe_u32 v6, v4, 2, 4
    v_bfe_u32 v7, v4, 6, 2
    v_lshrrev_b32 v8, 8, v4
    v_cmp_le_u32 vcc, 10, v8
    s_nop 1
    v_cndmask_b32 v9, 0, 1, vcc
    v_mul_u32_u24 v10, 10, v9
    v_sub_u32 v10, v8, v10
    v_lshl_add_u32 v11, v7, 2, v5
    v_mul_u32_u24 v11, 320, v11
    v_lshrrev_b32 v12, 1, v10
    v_lshl_add_u32 v11, v12, 6, v11
    v_lshl_add_u32 v11, v9, 5, v11
    v_and_b32 v12, 1, v10
    v_lshl_add_u32 v11, v12, 4, v11
    v_add_u32 v11, v11, v6
    v_lshlrev_b32 v11, 1, v11
    buffer_load_ushort v13, v11, s[16:19], 0 offen
    v_mov_b32 v30, 0x80000000
    v_add_u32 v14, 0, v8
    v_mul_u32_u24 v15, 26, v14
    v_lshrrev_b32 v15, 8, v15
    v_mul_u32_u24 v16, 10, v15
    v_sub_u32 v16, v14, v16
    v_lshrrev_b32 v17, 1, v16
    v_and_b32 v18, 1, v16
    v_lshl_add_u32 v19, v7, 2, v5
    v_lshl_add_u32 v19, v18, 5, v19
    v_lshl_add_u32 v19, v17, 6, v19
    v_lshrrev_b32 v20, 1, v15
    v_and_b32 v21, 1, v15
    v_lshrrev_b32 v22, 2, v6
    v_lshlrev_b32 v22, 3, v22
    v_lshl_add_u32 v22, v20, 5, v22
    v_lshl_add_u32 v22, v21, 2, v22
    v_and_b32 v23, 3, v6
    v_add_u32 v22, v22, v23
    v_lshl_add_u32 v22, v19, 6, v22
    v_lshlrev_b32 v22, 1, v22
    v_subrev_u32 v23, 16384, v22
    v_cmp_gt_u32 vcc, 2, v17
    s_nop 1
    v_cndmask_b32 v24, v30, v22, vcc
    v_cndmask_b32 v25, v23, v30, vcc
    buffer_load_ushort v32, v24, s[20:23], 0 offen
    buffer_load_ushort v33, v24, s[20:23], 0 offen offset:2048
    buffer_load_ushort v34, v25, s[24:27], 0 offen
    buffer_load_ushort v35, v25, s[24:27], 0 offen offset:2048
    v_add_u32 v14, 20, v8
    v_mul_u32_u24 v15, 26, v14
    v_lshrrev_b32 v15, 8, v15
    v_mul_u32_u24 v16, 10, v15
    v_sub_u32 v16, v14, v16
    v_lshrrev_b32 v17, 1, v16
    v_and_b32 v18, 1, v16
    v_lshl_add_u32 v19, v7, 2, v5
    v_lshl_add_u32 v19, v18, 5, v19
    v_lshl_add_u32 v19, v17, 6, v19
    v_lshrrev_b32 v20, 1, v15
    v_and_b32 v21, 1, v15
    v_lshrrev_b32 v22, 2, v6
    v_lshlrev_b32 v22, 3, v22
    v_lshl_add_u32 v22, v20, 5, v22
    v_lshl_add_u32 v22, v21, 2, v22
    v_and_b32 v23, 3, v6
    v_add_u32 v22, v22, v23
    v_lshl_add_u32 v22, v19, 6, v22
    v_lshlrev_b32 v22, 1, v22
    v_subrev_u32 v23, 16384, v22
    v_cmp_gt_u32 vcc, 2, v17
    s_nop 1
    v_cndmask_b32 v24, v30, v22, vcc
    v_cndmask_b32 v25, v23, v30, vcc
    buffer_load_ushort v40, v24, s[20:23], 0 offen
    buffer_load_ushort v41, v24, s[20:23], 0 offen offset:2048
    buffer_load_ushort v42, v25, s[24:27], 0 offen
    buffer_load_ushort v43, v25, s[24:27], 0 offen offset:2048
    v_lshlrev_b32 v4, 2, v4
    s_mov_b32 s61, 20480
    s_waitcnt vmcnt(0)
    v_lshlrev_b32 v13, 16, v13
    buffer_store_dword v13, v4, s[28:31], 0 offen sc1
    v_or_b32 v32, v32, v34
    v_or_b32 v33, v33, v35
    v_lshl_or_b32 v32, v33, 16, v32
    buffer_store_dword v32, v4, s[32:35], 0 offen sc1
    v_or_b32 v40, v40, v42
    v_or_b32 v41, v41, v43
    v_lshl_or_b32 v40, v41, 16, v40
    buffer_store_dword v40, v4, s[32:35], s61 offen sc1
    s_add_u32 s60, s60, 512
P1_prepd:
    s_waitcnt vmcnt(0)
    s_barrier
    s_cmp_lg_u32 s3, 0
    s_cbranch_scc1 P1_sa2
    s_cmp_lg_u32 s96, 0
    s_cbranch_scc1 P1_sa2_n_d
    s_mov_b32 s62, 0x100000
    v_mov_b32 v111, 0
P1_sa2_n_l:
    buffer_load_dword v110, v111, s[76:79], 0 offen sc1
    s_sub_u32 s62, s62, 1
    s_cbranch_scc1 P1_sa2_n_d
    s_waitcnt vmcnt(0)
    v_readfirstlane_b32 s96, v110
    s_nop 0
    s_cmp_eq_u32 s96, 0
    s_cbranch_scc1 P1_sa2_n_l
P1_sa2_n_d:
    v_and_b32 v111, 63, v0
    v_lshlrev_b32 v111, 10, v111
    v_mov_b32 v110, s96
    s_lshl_b32 s62, s2, 2
    s_add_u32 s62, s62, 0
    s_bfm_b64 exec, 16, 0
    buffer_store_dword v110, v111, s[84:87], s62 offen sc1
    s_mov_b64 exec, -1
P1_sa2:
P1_fin:
    s_waitcnt vmcnt(0)
P1_fin3:
    s_barrier
P1_fin4:
    s_cmp_lg_u32 s3, 0
    s_cbranch_scc1 P1_sb
    s_cmp_lg_u32 s96, 0
    s_cbranch_scc1 P1_sb_n_d
    s_mov_b32 s62, 0x100000
    v_mov_b32 v111, 0
P1_sb_n_l:
    buffer_load_dword v110, v111, s[76:79], 0 offen sc1
    s_sub_u32 s62, s62, 1
    s_cbranch_scc1 P1_sb_n_d
    s_waitcnt vmcnt(0)
    v_readfirstlane_b32 s96, v110
    s_nop 0
    s_cmp_eq_u32 s96, 0
    s_cbranch_scc1 P1_sb_n_l
P1_sb_n_d:
    v_and_b32 v111, 63, v0
    v_lshlrev_b32 v111, 10, v111
    v_mov_b32 v110, s96
    s_lshl_b32 s62, s2, 2
    s_add_u32 s62, s62, 16384
    s_bfm_b64 exec, 16, 0
    buffer_store_dword v110, v111, s[84:87], s62 offen sc1
    s_mov_b64 exec, -1
P1_sb:
    s_mov_b32 s38, 0
    s_mov_b32 s40, 3392
    s_load_dwordx2 s[56:57], s[0:1], 88
    s_load_dwordx2 s[54:55], s[0:1], 72
    s_cmp_lg_u32 s3, 0
    s_cbranch_scc1 POLL_A_d
    s_mov_b32 s61, 0x100000
POLL_A_l:
    s_and_b32 s62, s2, 15
    s_lshl_b32 s62, s62, 10
    s_add_u32 s62, s62, 0
    v_lshlrev_b32 v111, 4, v251
    buffer_load_dwordx4 v[112:115], v111, s[84:87], s62 offen sc1
    s_sub_u32 s61, s61, 1
    s_cbranch_scc1 POLL_A_d
    s_waitcnt vmcnt(0)
    v_xor_b32 v112, s96, v112
    v_xor_b32 v113, s96, v113
    v_xor_b32 v114, s96, v114
    v_xor_b32 v115, s96, v115
    v_or3_b32 v112, v112, v113, v114
    v_or_b32 v112, v112, v115
    v_cmp_ne_u32 vcc, 0, v112
    s_nop 0
    s_cmp_eq_u64 vcc, 0
    s_cbranch_scc1 POLL_A_d
    s_branch POLL_A_l
POLL_A_d:
    v_mov_b32 v110, 163392
    v_mov_b32 v111, s96
    s_cmp_lg_u32 s3, 0
    s_cbranch_scc1 TAG_W
    ds_write_b32 v110, v111
    s_waitcnt lgkmcnt(0)
TAG_W:
    s_barrier
    ds_read_b32 v111, v110
    s_waitcnt lgkmcnt(0)
    v_readfirstlane_b32 s96, v111
    s_branch ROUND0
ROUND:
    s_load_dwordx2 s[56:57], s[0:1], 88
    s_load_dwordx2 s[54:55], s[0:1], 72
ROUND0:
    v_and_b32 v2, 255, v250
    v_lshlrev_b32 v3, 10, v2
    v_and_b32 v251, 63, v250
    v_lshrrev_b32 v1, 6, v250
    s_nop 0
    v_readfirstlane_b32 s3, v1
    s_lshl_b32 s58, s2, 2
    s_cmp_eq_u32 s2, 255
    s_cselect_b32 s36, 5, 49
    s_waitcnt lgkmcnt(0)
    s_add_u32 s16, s56, 0
    s_addc_u32 s17, s57, 0
    s_mov_b32 s18, 256000
    s_mov_b32 s19, 0x20000
    s_cmp_ge_u32 s3, 4
    s_cbranch_scc1 NODESC
    buffer_load_dword v20, v3, s[16:19], s58 offen
NODESC:
    s_add_u32 s24, s56, 262144
    s_addc_u32 s25, s57, 0
    s_mov_b32 s26, 73728
    s_mov_b32 s27, 0x20000
    s_add_u32 s12, s56, 1048576
    s_addc_u32 s13, s57, 0
    s_mov_b32 s14, 9600000
    s_mov_b32 s15, 0x20000
    s_add_u32 s8, s56, 18874368
    s_addc_u32 s9, s57, 0
    s_mov_b32 s10, 25600000
    s_mov_b32 s11, 0x20000
    s_add_u32 s4, s56, 11532288
    s_addc_u32 s5, s57, 0
    s_mov_b32 s6, 6402048
    s_mov_b32 s7, 0x20000
    s_mul_i32 s59, s2, 77824
    s_add_u32 s59, s59, 45088768
    s_add_u32 s20, s56, s59
    s_addc_u32 s21, s57, 0
    s_mov_b32 s22, 76832
    s_mov_b32 s23, 0x20000
    s_lshl_b32 s59, s2, 16
    s_add_u32 s59, s59, 67108864
    s_add_u32 s32, s56, s59
    s_addc_u32 s33, s57, 0
    s_mov_b32 s34, 65536
    s_mov_b32 s35, 0x20000
    s_mul_i32 s59, s2, 25088
    s_lshl_b32 s60, s36, 9
    s_add_u32 s28, s54, s59
    s_addc_u32 s29, s55, 0
    s_mov_b32 s30, s60
    s_mov_b32 s31, 0x20000
    s_mul_i32 s51, s3, 6336
    s_add_u32 s51, s51, 108576
    s_mov_b32 s100, 0xffff0000
    s_mov_b32 s101, 0x80008000
    v_bfe_u32 v3, v251, 4, 1
    v_and_b32 v4, 7, v251
    v_lshlrev_b32 v5, 1, v3
    v_xor_b32 v4, v4, v5
    v_lshlrev_b32 v4, 4, v4
    v_add_u32 v228, 2147485696, v4
    v_add_u32 v229, 2147484608, v4
    v_and_b32 v4, 3, v251
    v_lshlrev_b32 v230, 3, v4
    v_bfe_u32 v5, v251, 3, 1
    v_mul_u32_u24 v5, 1088, v5
    v_lshrrev_b32 v6, 4, v251
    v_lshl_add_u32 v5, v6, 8, v5
    v_bfe_u32 v7, v251, 2, 1
    v_lshl_add_u32 v5, v7, 7, v5
    v_add_u32 v5, v5, v230
    v_add_u32 v5, s51, v5
    v_lshlrev_b32 v7, 5, v3
    v_add_u32 v231, v5, v7
    v_sub_u32 v232, v5, v7
    v_and_b32 v7, 15, v251
    v_lshlrev_b32 v8, 2, v7
    v_lshl_add_u32 v233, v6, 6, v8
    v_and_b32 v8, 1, v7
    v_lshlrev_b32 v8, 4, v8
    v_mov_b32 v9, 0x3f80
    v_lshlrev_b32 v8, v8, v9
    v_and_b32 v9, 14, v7
    v_cmp_eq_u32 vcc, 0, v9
    s_nop 1
    v_cndmask_b32 v184, 0, v8, vcc
    v_cmp_eq_u32 vcc, 4, v9
    s_nop 1
    v_cndmask_b32 v185, 0, v8, vcc
    v_cmp_eq_u32 vcc, 8, v9
    s_nop 1
    v_cndmask_b32 v186, 0, v8, vcc
    v_cmp_eq_u32 vcc, 12, v9
    s_nop 1
    v_cndmask_b32 v187, 0, v8, vcc
    v_lshlrev_b32 v6, 2, v250
    v_mov_b32 v7, 0
    v_add_u32 v8, 163104, v6
    v_cmp_gt_u32 vcc, 68, v250
    s_nop 0
    s_and_saveexec_b64 s[58:59], vcc
    ds_write_b32 v8, v7
    v_cmp_gt_u32 vcc, 8, v250
    s_nop 0
    s_and_b64 exec, exec, vcc
    ds_write_b32 v6, v7
    s_mov_b64 exec, -1
    v_lshlrev_b32 v13, 4, v250
    v_add_u32 v13, 108576, v13
    v_mov_b32 v28, 0
    v_mov_b32 v29, 0
    v_mov_b32 v30, 0
    v_mov_b32 v31, 0
    ds_write_b128 v13, v[28:31] offset:0
    ds_write_b128 v13, v[28:31] offset:8192
    ds_write_b128 v13, v[28:31] offset:16384
    ds_write_b128 v13, v[28:31] offset:24576
    ds_write_b128 v13, v[28:31] offset:32768
    ds_write_b128 v13, v[28:31] offset:40960
    v_cmp_gt_u32 vcc, 336, v250
    s_nop 0
    s_mov_b64 exec, vcc
    ds_write_b128 v13, v[28:31] offset:49152
    s_mov_b64 exec, -1
    v_mul_u32_u24 v14, 3200, v2
    v_lshrrev_b32 v15, 8, v250
    v_mov_b32 v16, 0x80000000
    s_and_b32 s59, s3, 3
    v_lshlrev_b32 v22, 3, v2
    v_add_u32 v22, 1024, v22
    s_cmp_ge_u32 s3, 4
    s_cbranch_scc1 NOSCAN
    s_waitcnt vmcnt(0)
    v_lshrrev_b32 v9, 16, v20
    v_mov_b32 v21, v9
    s_nop 1
    v_add_u32_dpp v21, v21, v21 row_shr:1 row_mask:0xf bank_mask:0xf bound_ctrl:1
    s_nop 1
    v_add_u32_dpp v21, v21, v21 row_shr:2 row_mask:0xf bank_mask:0xf bound_ctrl:1
    s_nop 1
    v_add_u32_dpp v21, v21, v21 row_shr:4 row_mask:0xf bank_mask:0xf bound_ctrl:1
    s_nop 1
    v_add_u32_dpp v21, v21, v21 row_shr:8 row_mask:0xf bank_mask:0xf bound_ctrl:1
    s_nop 1
    v_add_u32_dpp v21, v21, v21 row_bcast:15 row_mask:0xa bank_mask:0xf
    s_nop 1
    v_add_u32_dpp v21, v21, v21 row_bcast:31 row_mask:0xc bank_mask:0xf
    s_nop 0
    v_readlane_b32 s58, v21, 63
    s_lshl_b32 s60, s59, 2
    s_add_u32 s60, s60, 163376
    v_mov_b32 v12, s60
    v_mov_b32 v13, s58
    ds_write_b32 v12, v13
    v_sub_u32 v21, v21, v9
    ds_write_b64 v22, v[20:21]
NOSCAN:
    v_mov_b32 v12, 163376
    s_waitcnt lgkmcnt(0)
    s_barrier
    ds_read_b128 v[16:19], v12
    ds_read_b64 v[20:21], v22
    s_waitcnt lgkmcnt(0)
    v_lshrrev_b32 v9, 16, v20
    v_and_b32 v10, 0xffff, v20
    v_add_u32 v14, v14, v10
    v_mov_b32 v11, v21
    v_readfirstlane_b32 s60, v16
    v_readfirstlane_b32 s61, v17
    v_readfirstlane_b32 s62, v18
    v_readfirstlane_b32 s63, v19
    s_add_u32 s61, s61, s60
    s_add_u32 s62, s62, s61
    s_add_u32 s37, s63, s62
    s_cmp_eq_u32 s59, 0
    s_cselect_b32 s58, 0, s60
    s_cmp_eq_u32 s59, 2
    s_cselect_b32 s58, s61, s58
    s_cmp_eq_u32 s59, 3
    s_cselect_b32 s58, s62, s58
    v_mov_b32 v16, 0x80000000
    s_sub_u32 s39, s37, s38
    s_cmp_le_u32 s39, s40
    s_cselect_b32 s78, 1, 0
    s_min_u32 s39, s39, s40
    s_sub_u32 s58, s58, s38
    v_add_u32 v11, s58, v11
    v_sub_u32 v12, 0, v11
    v_max_i32 v12, 0, v12
    v_sub_u32 v13, s39, v11
    v_min_i32 v13, v13, v9
    v_add_u32 v12, v12, v15
    v_sub_u32 v9, v13, v12
    v_add_u32 v14, v14, v12
    v_add_u32 v11, v11, v12
    v_lshlrev_b32 v12, 2, v11
    v_add_u32 v12, 94208, v12
MAPL:
    v_cmp_lt_i32 vcc, 0, v9
    s_nop 0
    s_and_b64 exec, exec, vcc
    s_cbranch_execz MAPD
    ds_write_b32 v12, v14 offset:0
    v_cmp_lt_i32 vcc, 2, v9
    v_add_u32 v14, 2, v14
    s_and_b64 exec, exec, vcc
    ds_write_b32 v12, v14 offset:8
    v_cmp_lt_i32 vcc, 4, v9
    v_add_u32 v14, 2, v14
    s_and_b64 exec, exec, vcc
    ds_write_b32 v12, v14 offset:16
    v_cmp_lt_i32 vcc, 6, v9
    v_add_u32 v14, 2, v14
    s_and_b64 exec, exec, vcc
    ds_write_b32 v12, v14 offset:24
    v_cmp_lt_i32 vcc, 8, v9
    v_add_u32 v14, 2, v14
    s_and_b64 exec, exec, vcc
    s_cbranch_execz MAPD
    ds_write_b32 v12, v14 offset:32
    v_cmp_lt_i32 vcc, 10, v9
    v_add_u32 v14, 2, v14
    s_and_b64 exec, exec, vcc
    ds_write_b32 v12, v14 offset:40
    v_cmp_lt_i32 vcc, 12, v9
    v_add_u32 v14, 2, v14
    s_and_b64 exec, exec, vcc
    ds_write_b32 v12, v14 offset:48
    v_cmp_lt_i32 vcc, 14, v9
    v_add_u32 v14, 2, v14
    s_and_b64 exec, exec, vcc
    ds_write_b32 v12, v14 offset:56
    v_cmp_lt_i32 vcc, 16, v9
    v_add_u32 v14, 2, v14
    s_and_b64 exec, exec, vcc
    s_cbranch_execz MAPD
    ds_write_b32 v12, v14 offset:64
    v_cmp_lt_i32 vcc, 18, v9
    v_add_u32 v14, 2, v14
    s_and_b64 exec, exec, vcc
    ds_write_b32 v12, v14 offset:72
    v_cmp_lt_i32 vcc, 20, v9
    v_add_u32 v14, 2, v14
    s_and_b64 exec, exec, vcc
    ds_write_b32 v12, v14 offset:80
    v_cmp_lt_i32 vcc, 22, v9
    v_add_u32 v14, 2, v14
    s_and_b64 exec, exec, vcc
    ds_write_b32 v12, v14 offset:88
    v_cmp_lt_i32 vcc, 24, v9
    v_add_u32 v14, 2, v14
    s_and_b64 exec, exec, vcc
    s_cbranch_execz MAPD
    ds_write_b32 v12, v14 offset:96
    v_cmp_lt_i32 vcc, 26, v9
    v_add_u32 v14, 2, v14
    s_and_b64 exec, exec, vcc
    ds_write_b32 v12, v14 offset:104
    v_cmp_lt_i32 vcc, 28, v9
    v_add_u32 v14, 2, v14
    s_and_b64 exec, exec, vcc
    ds_write_b32 v12, v14 offset:112
    v_cmp_lt_i32 vcc, 30, v9
    v_add_u32 v14, 2, v14
    s_and_b64 exec, exec, vcc
    ds_write_b32 v12, v14 offset:120
    v_add_u32 v14, 2, v14
    v_add_u32 v12, 128, v12
    v_subrev_u32 v9, 32, v9
    s_branch MAPL
MAPD:
    s_mov_b64 exec, -1
    v_add_u32 v12, 94208, v6
    v_lshrrev_b32 v13, 1, v251
    s_lshl_b32 s58, s3, 5
    v_add_u32 v13, s58, v13
    v_lshl_add_u32 v14, v13, 2, v7
    v_add_u32 v14, 94208, v14
    v_and_b32 v15, 1, v251
    v_lshlrev_b32 v15, 4, v15
    s_waitcnt lgkmcnt(0)
    s_barrier
    ds_read_b32 v20, v12 offset:0
    ds_read_b32 v21, v12 offset:2048
    ds_read_b32 v22, v12 offset:4096
    ds_read_b32 v23, v12 offset:6144
    ds_read_b32 v24, v12 offset:8192
    ds_read_b32 v25, v12 offset:10240
    ds_read_b32 v26, v12 offset:12288
    ds_read_b32 v28, v14 offset:0
    ds_read_b32 v29, v14 offset:1024
    ds_read_b32 v30, v14 offset:2048
    ds_read_b32 v31, v14 offset:3072
    ds_read_b32 v32, v14 offset:4096
    ds_read_b32 v33, v14 offset:5120
    ds_read_b32 v34, v14 offset:6144
    ds_read_b32 v35, v14 offset:7168
    ds_read_b32 v36, v14 offset:8192
    ds_read_b32 v37, v14 offset:9216
    ds_read_b32 v38, v14 offset:10240
    ds_read_b32 v39, v14 offset:11264
    ds_read_b32 v40, v14 offset:12288
    ds_read_b32 v41, v14 offset:13312
    v_add_u32 v17, 0, v250
    v_cmp_gt_u32 s[64:65], s39, v17
    s_waitcnt lgkmcnt(15)
    v_mul_u32_u24 v20, 12, v20
    v_cndmask_b32 v20, v16, v20, s[64:65]
    v_add_u32 v17, 512, v250
    v_cmp_gt_u32 s[66:67], s39, v17
    s_waitcnt lgkmcnt(15)
    v_mul_u32_u24 v21, 12, v21
    v_cndmask_b32 v21, v16, v21, s[66:67]
    v_add_u32 v17, 1024, v250
    v_cmp_gt_u32 s[68:69], s39, v17
    s_waitcnt lgkmcnt(15)
    v_mul_u32_u24 v22, 12, v22
    v_cndmask_b32 v22, v16, v22, s[68:69]
    v_add_u32 v17, 1536, v250
    v_cmp_gt_u32 s[70:71], s39, v17
    s_waitcnt lgkmcnt(15)
    v_mul_u32_u24 v23, 12, v23
    v_cndmask_b32 v23, v16, v23, s[70:71]
    v_add_u32 v17, 2048, v250
    v_cmp_gt_u32 s[72:73], s39, v17
    s_waitcnt lgkmcnt(15)
    v_mul_u32_u24 v24, 12, v24
    v_cndmask_b32 v24, v16, v24, s[72:73]
    v_add_u32 v17, 2560, v250
    v_cmp_gt_u32 s[74:75], s39, v17
    s_waitcnt lgkmcnt(15)
    v_mul_u32_u24 v25, 12, v25
    v_cndmask_b32 v25, v16, v25, s[74:75]
    v_add_u32 v17, 3072, v250
    v_cmp_gt_u32 s[76:77], s39, v17
    s_waitcnt lgkmcnt(14)
    v_mul_u32_u24 v26, 12, v26
    v_cndmask_b32 v26, v16, v26, s[76:77]
    buffer_load_dwordx3 v[44:46], v20, s[12:15], 0 offen sc1
    buffer_load_dwordx3 v[48:50], v21, s[12:15], 0 offen sc1
    buffer_load_dwordx3 v[52:54], v22, s[12:15], 0 offen sc1
    buffer_load_dwordx3 v[56:58], v23, s[12:15], 0 offen sc1
    buffer_load_dwordx3 v[60:62], v24, s[12:15], 0 offen sc1
    buffer_load_dwordx3 v[64:66], v25, s[12:15], 0 offen sc1
    buffer_load_dwordx3 v[68:70], v26, s[12:15], 0 offen sc1
    s_waitcnt lgkmcnt(0)
    s_lshl_b32 s57, s3, 10
    s_add_u32 s57, s57, 32
    v_cmp_gt_u32 vcc, s39, v13
    v_lshl_add_u32 v28, v28, 5, v15
    v_add_u32 v13, 256, v13
    v_cndmask_b32 v128, v16, v28, vcc
    v_cmp_gt_u32 vcc, s39, v13
    v_lshl_add_u32 v29, v29, 5, v15
    v_add_u32 v13, 256, v13
    v_cndmask_b32 v129, v16, v29, vcc
    v_cmp_gt_u32 vcc, s39, v13
    v_lshl_add_u32 v30, v30, 5, v15
    v_add_u32 v13, 256, v13
    v_cndmask_b32 v130, v16, v30, vcc
    v_cmp_gt_u32 vcc, s39, v13
    v_lshl_add_u32 v31, v31, 5, v15
    v_add_u32 v13, 256, v13
    v_cndmask_b32 v131, v16, v31, vcc
    v_cmp_gt_u32 vcc, s39, v13
    v_lshl_add_u32 v32, v32, 5, v15
    v_add_u32 v13, 256, v13
    v_cndmask_b32 v132, v16, v32, vcc
    v_cmp_gt_u32 vcc, s39, v13
    v_lshl_add_u32 v33, v33, 5, v15
    v_add_u32 v13, 256, v13
    v_cndmask_b32 v133, v16, v33, vcc
    v_cmp_gt_u32 vcc, s39, v13
    v_lshl_add_u32 v34, v34, 5, v15
    v_add_u32 v13, 256, v13
    v_cndmask_b32 v134, v16, v34, vcc
    v_cmp_gt_u32 vcc, s39, v13
    v_lshl_add_u32 v35, v35, 5, v15
    v_add_u32 v13, 256, v13
    v_cndmask_b32 v135, v16, v35, vcc
    v_cmp_gt_u32 vcc, s39, v13
    v_lshl_add_u32 v36, v36, 5, v15
    v_add_u32 v13, 256, v13
    v_cndmask_b32 v136, v16, v36, vcc
    v_cmp_gt_u32 vcc, s39, v13
    v_lshl_add_u32 v37, v37, 5, v15
    v_add_u32 v13, 256, v13
    v_cndmask_b32 v137, v16, v37, vcc
    v_cmp_gt_u32 vcc, s39, v13
    v_lshl_add_u32 v38, v38, 5, v15
    v_add_u32 v13, 256, v13
    v_cndmask_b32 v138, v16, v38, vcc
    v_cmp_gt_u32 vcc, s39, v13
    v_lshl_add_u32 v39, v39, 5, v15
    v_add_u32 v13, 256, v13
    v_cndmask_b32 v139, v16, v39, vcc
    v_cmp_gt_u32 vcc, s39, v13
    v_lshl_add_u32 v40, v40, 5, v15
    v_add_u32 v13, 256, v13
    v_cndmask_b32 v140, v16, v40, vcc
    v_cmp_gt_u32 vcc, s39, v13
    v_lshl_add_u32 v41, v41, 5, v15
    v_add_u32 v13, 256, v13
    v_cndmask_b32 v141, v16, v41, vcc
    s_and_b32 s62, s2, 15
    s_lshl_b32 s62, s62, 10
    s_add_u32 s62, s62, 16384
    v_lshlrev_b32 v111, 4, v251
    buffer_load_dwordx4 v[112:115], v111, s[84:87], s62 offen sc1
    v_mov_b32 v17, 1
    s_waitcnt vmcnt(7)
    v_and_b32 v20, 0xff, v44
    v_lshlrev_b32 v20, 2, v20
    v_add_u32 v18, 163104, v20
    s_mov_b64 exec, s[64:65]
    ds_add_rtn_u32 v47, v18, v17
    s_mov_b64 exec, -1
    s_waitcnt vmcnt(6)
    v_and_b32 v21, 0xff, v48
    v_lshlrev_b32 v21, 2, v21
    v_add_u32 v18, 163104, v21
    s_mov_b64 exec, s[66:67]
    ds_add_rtn_u32 v51, v18, v17
    s_mov_b64 exec, -1
    s_waitcnt vmcnt(5)
    v_and_b32 v22, 0xff, v52
    v_lshlrev_b32 v22, 2, v22
    v_add_u32 v18, 163104, v22
    s_mov_b64 exec, s[68:69]
    ds_add_rtn_u32 v55, v18, v17
    s_mov_b64 exec, -1
    s_waitcnt vmcnt(4)
    v_and_b32 v23, 0xff, v56
    v_lshlrev_b32 v23, 2, v23
    v_add_u32 v18, 163104, v23
    s_mov_b64 exec, s[70:71]
    ds_add_rtn_u32 v59, v18, v17
    s_mov_b64 exec, -1
    s_waitcnt vmcnt(3)
    v_and_b32 v24, 0xff, v60
    v_lshlrev_b32 v24, 2, v24
    v_add_u32 v18, 163104, v24
    s_mov_b64 exec, s[72:73]
    ds_add_rtn_u32 v63, v18, v17
    s_mov_b64 exec, -1
    s_waitcnt vmcnt(2)
    v_and_b32 v25, 0xff, v64
    v_lshlrev_b32 v25, 2, v25
    v_add_u32 v18, 163104, v25
    s_mov_b64 exec, s[74:75]
    ds_add_rtn_u32 v67, v18, v17
    s_mov_b64 exec, -1
    s_waitcnt vmcnt(1)
    v_and_b32 v26, 0xff, v68
    v_lshlrev_b32 v26, 2, v26
    v_add_u32 v18, 163104, v26
    s_mov_b64 exec, s[76:77]
    ds_add_rtn_u32 v71, v18, v17
    s_mov_b64 exec, -1
    v_lshlrev_b32 v12, 2, v251
    v_add_u32 v12, 163104, v12
    v_lshlrev_b32 v35, 2, v250
    v_add_u32 v35, 4, v35
    v_and_b32 v44, 0xffffff00, v44
    v_add_u32 v36, 0, v35
    v_or_b32 v145, v46, v36
    v_mov_b32 v144, v45
    v_and_b32 v48, 0xffffff00, v48
    v_add_u32 v36, 2048, v35
    v_or_b32 v147, v50, v36
    v_mov_b32 v146, v49
    v_and_b32 v52, 0xffffff00, v52
    v_add_u32 v36, 4096, v35
    v_or_b32 v149, v54, v36
    v_mov_b32 v148, v53
    v_and_b32 v56, 0xffffff00, v56
    v_add_u32 v36, 6144, v35
    v_or_b32 v151, v58, v36
    v_mov_b32 v150, v57
    v_and_b32 v60, 0xffffff00, v60
    v_add_u32 v36, 8192, v35
    v_or_b32 v153, v62, v36
    v_mov_b32 v152, v61
    v_and_b32 v64, 0xffffff00, v64
    v_add_u32 v36, 10240, v35
    v_or_b32 v155, v66, v36
    v_mov_b32 v154, v65
    v_and_b32 v68, 0xffffff00, v68
    v_add_u32 v36, 12288, v35
    v_or_b32 v157, v70, v36
    v_mov_b32 v156, v69
    v_lshrrev_b32 v164, 4, v251
    v_lshlrev_b32 v164, 2, v164
    v_bfe_u32 v165, v251, 2, 1
    v_lshl_add_u32 v160, v165, 5, v164
    v_bfe_u32 v165, v251, 1, 1
    v_lshl_add_u32 v160, v165, 4, v160
    v_lshl_add_u32 v161, v165, 5, v164
    v_and_b32 v165, 1, v251
    v_lshl_add_u32 v160, v165, 1, v160
    v_lshl_add_u32 v161, v165, 4, v161
    v_bfe_u32 v165, v251, 3, 1
    v_add_u32 v160, v160, v165
    v_bfe_u32 v165, v251, 2, 2
    v_add_u32 v161, v161, v165
    v_mov_b32 v162, 126752
    v_mov_b32 v163, 108576
    v_lshl_add_u32 v160, v160, 2, v163
    v_lshl_add_u32 v161, v161, 3, v162
    s_waitcnt vmcnt(0)
    v_xor_b32 v112, s96, v112
    v_xor_b32 v113, s96, v113
    v_xor_b32 v114, s96, v114
    v_xor_b32 v115, s96, v115
    v_or3_b32 v112, v112, v113, v114
    v_or_b32 v112, v112, v115
    v_cmp_ne_u32 vcc, 0, v112
    s_nop 0
    s_cmp_eq_u64 vcc, 0
    s_cselect_b32 s88, 1, 0
    s_waitcnt lgkmcnt(0)
    s_barrier
    s_mov_b32 s89, s88
    s_cmp_eq_u32 s88, 0
    s_cbranch_scc1 EB1_skip
    s_mov_b32 m0, s57
    s_add_u32 s57, s57, 8192
    buffer_load_dwordx4 v128, s[8:11], 0 offen sc1 lds
    s_mov_b32 m0, s57
    s_add_u32 s57, s57, 8192
    buffer_load_dwordx4 v129, s[8:11], 0 offen sc1 lds
    s_mov_b32 m0, s57
    s_add_u32 s57, s57, 8192
    buffer_load_dwordx4 v130, s[8:11], 0 offen sc1 lds
    s_mov_b32 m0, s57
    s_add_u32 s57, s57, 8192
    buffer_load_dwordx4 v131, s[8:11], 0 offen sc1 lds
    s_mov_b32 m0, s57
    s_add_u32 s57, s57, 8192
    buffer_load_dwordx4 v132, s[8:11], 0 offen sc1 lds
    s_branch EB1_done
EB1_skip:
    s_and_b32 s62, s2, 15
    s_lshl_b32 s62, s62, 10
    s_add_u32 s62, s62, 16384
    v_lshlrev_b32 v111, 4, v251
    buffer_load_dwordx4 v[112:115], v111, s[84:87], s62 offen sc1
EB1_done:
    ds_read_b32 v14, v12
    s_waitcnt lgkmcnt(0)
    v_add_u32 v14, 31, v14
    v_lshrrev_b32 v14, 5, v14
    v_max_u32 v14, 1, v14
    v_cmp_gt_u32 s[60:61], s36, v251
    s_nop 1
    v_cndmask_b32 v14, 0, v14, s[60:61]
    v_cmp_lt_u32 vcc, 2, v14
    s_nop 0
    s_andn2_b64 s[60:61], s[60:61], vcc
    s_bcnt1_i32_b64 s62, vcc
    s_bcnt1_i32_b64 s63, s[60:61]
    v_mbcnt_lo_u32_b32 v32, vcc_lo, 0
    v_mbcnt_hi_u32_b32 v32, vcc_hi, v32
    v_mov_b32 v33, s62
    v_mbcnt_lo_u32_b32 v33, s60, v33
    v_mbcnt_hi_u32_b32 v33, s61, v33
    v_cndmask_b32 v32, v33, v32, vcc
    v_cmp_gt_u32 vcc, s36, v251
    s_nop 1
    v_cndmask_b32 v32, v251, v32, vcc
    v_lshlrev_b32 v32, 2, v32
    v_lshl_or_b32 v33, v251, 8, v14
    ds_permute_b32 v34, v32, v33
    v_mad_u32_u24 v36, v251, s36, 7
    v_lshrrev_b32 v36, 3, v36
    s_mul_i32 s58, s62, 10
    s_mul_i32 s59, s36, 26
    s_add_u32 s58, s58, s59
    v_mad_u32_u24 v37, v251, s58, 40
    v_mul_u32_u24 v40, 208, v36
    v_sub_u32 v37, v37, v40
    v_max_i32 v37, 0, v37
    v_mul_u32_u24 v37, 3277, v37
    v_lshrrev_b32 v37, 18, v37
    v_subrev_u32 v40, s63, v36
    v_max_i32 v37, v37, v40
    v_min_u32 v37, s62, v37
    v_min_u32 v37, v37, v36
    s_nop 1
    v_max_u32_dpp v37, v37, v37 row_shr:1 row_mask:0xf bank_mask:0xf bound_ctrl:1
    s_nop 1
    v_max_u32_dpp v37, v37, v37 row_shr:2 row_mask:0xf bank_mask:0xf bound_ctrl:1
    s_nop 1
    v_max_u32_dpp v37, v37, v37 row_shr:4 row_mask:0xf bank_mask:0xf bound_ctrl:1
    s_nop 1
    v_max_u32_dpp v37, v37, v37 row_shr:8 row_mask:0xf bank_mask:0xf bound_ctrl:1
    v_sub_u32 v40, v36, v37
    s_nop 1
    v_max_u32_dpp v40, v40, v40 row_shr:1 row_mask:0xf bank_mask:0xf bound_ctrl:1
    s_nop 1
    v_max_u32_dpp v40, v40, v40 row_shr:2 row_mask:0xf bank_mask:0xf bound_ctrl:1
    s_nop 1
    v_max_u32_dpp v40, v40, v40 row_shr:4 row_mask:0xf bank_mask:0xf bound_ctrl:1
    s_nop 1
    v_max_u32_dpp v40, v40, v40 row_shr:8 row_mask:0xf bank_mask:0xf bound_ctrl:1
    v_sub_u32 v37, v36, v40
    v_lshl_or_b32 v37, v36, 8, v37
    s_cmp_eq_u32 s36, 49
    s_mov_b32 s58, 104858
    s_cmov_b32 s58, 10700
    v_mul_u32_u24 v40, s58, v251
    v_lshrrev_b32 v40, 16, v40
    v_min_u32 v40, 7, v40
    v_lshlrev_b32 v40, 2, v40
    ds_bpermute_b32 v41, v40, v37
    ds_bpermute_b32 v42, v40, v37 offset:4
    s_and_b32 s60, s3, 3
    s_lshl_b32 s60, s60, 1
    s_lshr_b32 s61, s3, 2
    s_add_u32 s59, s60, s61
    s_mul_i32 s60, s59, s36
    s_add_u32 s61, s60, s36
    s_add_u32 s60, s60, 7
    s_add_u32 s61, s61, 7
    s_lshr_b32 s41, s60, 3
    s_lshr_b32 s79, s61, 3
    s_sub_u32 s42, s79, s41
    s_waitcnt lgkmcnt(0)
    v_lshrrev_b32 v43, 8, v41
    v_lshrrev_b32 v33, 8, v42
    v_add3_u32 v33, v33, v43, -1
    v_sub_u32 v33, v33, v251
    v_and_b32 v40, 4, v40
    v_cmp_eq_u32 vcc, 0, v40
    s_nop 1
    v_cndmask_b32 v33, v33, v251, vcc
    v_and_b32 v41, 0xff, v41
    v_and_b32 v42, 0xff, v42
    v_sub_u32 v43, v33, v43
    v_add_u32 v43, v43, v41
    v_sub_u32 v40, v33, v42
    v_add_u32 v40, s62, v40
    v_cmp_lt_u32 vcc, v43, v42
    s_nop 1
    v_cndmask_b32 v40, v40, v43, vcc
    v_cmp_gt_u32 vcc, s36, v251
    s_nop 1
    v_cndmask_b32 v40, v251, v40, vcc
    v_lshlrev_b32 v40, 2, v40
    ds_bpermute_b32 v41, v40, v34
    s_waitcnt lgkmcnt(0)
    v_and_b32 v14, 0xff, v41
    v_subrev_u32 v234, 1, v14
    v_lshrrev_b32 v218, 8, v41
    v_lshlrev_b32 v41, 2, v218
    v_mov_b32 v19, v14
    s_nop 1
    v_add_u32_dpp v19, v19, v19 row_shr:1 row_mask:0xf bank_mask:0xf bound_ctrl:1
    s_nop 1
    v_add_u32_dpp v19, v19, v19 row_shr:2 row_mask:0xf bank_mask:0xf bound_ctrl:1
    s_nop 1
    v_add_u32_dpp v19, v19, v19 row_shr:4 row_mask:0xf bank_mask:0xf bound_ctrl:1
    s_nop 1
    v_add_u32_dpp v19, v19, v19 row_shr:8 row_mask:0xf bank_mask:0xf bound_ctrl:1
    s_nop 1
    v_add_u32_dpp v19, v19, v19 row_bcast:15 row_mask:0xa bank_mask:0xf
    s_nop 1
    v_add_u32_dpp v19, v19, v19 row_bcast:31 row_mask:0xc bank_mask:0xf
    v_sub_u32 v42, v19, v14
    ds_permute_b32 v18, v41, v42
    v_min_u32 v36, 63, v36
    v_lshlrev_b32 v36, 2, v36
    ds_bpermute_b32 v43, v36, v42
    v_readlane_b32 s58, v19, 63
    s_waitcnt lgkmcnt(0)
    v_mov_b32 v40, v43
    v_sub_u32_dpp v40, v43, v43 row_shl:1 row_mask:0xf bank_mask:0xf
    v_readlane_b32 s43, v43, s59
    v_cmp_lt_u32 vcc, 20, v40
    v_readlane_b32 s44, v40, s59
    s_and_b32 s60, vcc_lo, 0xff
    ds_bpermute_b32 v20, v20, v18
    ds_bpermute_b32 v21, v21, v18
    ds_bpermute_b32 v22, v22, v18
    ds_bpermute_b32 v23, v23, v18
    ds_bpermute_b32 v24, v24, v18
    ds_bpermute_b32 v25, v25, v18
    ds_bpermute_b32 v26, v26, v18
    s_lshl_b32 s59, s43, 7
    v_add_u32 v160, s59, v160
    s_lshl_b32 s59, s59, 1
    v_add_u32 v161, s59, v161
    s_cmp_gt_u32 s58, 142
    s_cselect_b32 s60, 1, s60
    s_cmp_eq_u32 s60, 0
    s_cbranch_scc1 SCATTER
    s_mov_b32 s40, 256
    s_waitcnt vmcnt(0) lgkmcnt(0)
    s_barrier
    s_branch ROUND
SCATTER:
    s_cmp_lg_u32 s88, 0
    s_cbranch_scc1 EB2_go
    s_waitcnt vmcnt(0)
    v_xor_b32 v112, s96, v112
    v_xor_b32 v113, s96, v113
    v_xor_b32 v114, s96, v114
    v_xor_b32 v115, s96, v115
    v_or3_b32 v112, v112, v113, v114
    v_or_b32 v112, v112, v115
    v_cmp_ne_u32 vcc, 0, v112
    s_nop 0
    s_cmp_eq_u64 vcc, 0
    s_cselect_b32 s89, 1, 0
    s_cbranch_scc0 EB2_skip
    s_mov_b32 m0, s57
    s_add_u32 s57, s57, 8192
    buffer_load_dwordx4 v128, s[8:11], 0 offen sc1 lds
    s_mov_b32 m0, s57
    s_add_u32 s57, s57, 8192
    buffer_load_dwordx4 v129, s[8:11], 0 offen sc1 lds
    s_mov_b32 m0, s57
    s_add_u32 s57, s57, 8192
    buffer_load_dwordx4 v130, s[8:11], 0 offen sc1 lds
    s_mov_b32 m0, s57
    s_add_u32 s57, s57, 8192
    buffer_load_dwordx4 v131, s[8:11], 0 offen sc1 lds
    s_mov_b32 m0, s57
    s_add_u32 s57, s57, 8192
    buffer_load_dwordx4 v132, s[8:11], 0 offen sc1 lds
EB2_go:
    s_mov_b32 m0, s57
    s_add_u32 s57, s57, 8192
    buffer_load_dwordx4 v133, s[8:11], 0 offen sc1 lds
    s_mov_b32 m0, s57
    s_add_u32 s57, s57, 8192
    buffer_load_dwordx4 v134, s[8:11], 0 offen sc1 lds
    s_mov_b32 m0, s57
    s_add_u32 s57, s57, 8192
    buffer_load_dwordx4 v135, s[8:11], 0 offen sc1 lds
    s_mov_b32 m0, s57
    s_add_u32 s57, s57, 8192
    buffer_load_dwordx4 v136, s[8:11], 0 offen sc1 lds
    s_mov_b32 m0, s57
    s_add_u32 s57, s57, 8192
    buffer_load_dwordx4 v137, s[8:11], 0 offen sc1 lds
EB2_skip:
    s_waitcnt lgkmcnt(6)
    v_lshl_add_u32 v20, v20, 5, v47
    v_lshl_add_u32 v45, v20, 3, v162
    v_lshl_add_u32 v20, v20, 2, v163
    s_mov_b64 exec, s[64:65]
    ds_write_b32 v20, v44
    ds_write_b64 v45, v[144:145]
    s_mov_b64 exec, -1
    s_waitcnt lgkmcnt(7)
    v_lshl_add_u32 v21, v21, 5, v51
    v_lshl_add_u32 v49, v21, 3, v162
    v_lshl_add_u32 v21, v21, 2, v163
    s_mov_b64 exec, s[66:67]
    ds_write_b32 v21, v48
    ds_write_b64 v49, v[146:147]
    s_mov_b64 exec, -1
    s_waitcnt lgkmcnt(8)
    v_lshl_add_u32 v22, v22, 5, v55
    v_lshl_add_u32 v53, v22, 3, v162
    v_lshl_add_u32 v22, v22, 2, v163
    s_mov_b64 exec, s[68:69]
    ds_write_b32 v22, v52
    ds_write_b64 v53, v[148:149]
    s_mov_b64 exec, -1
    s_waitcnt lgkmcnt(9)
    v_lshl_add_u32 v23, v23, 5, v59
    v_lshl_add_u32 v57, v23, 3, v162
    v_lshl_add_u32 v23, v23, 2, v163
    s_mov_b64 exec, s[70:71]
    ds_write_b32 v23, v56
    ds_write_b64 v57, v[150:151]
    s_mov_b64 exec, -1
    s_waitcnt lgkmcnt(10)
    v_lshl_add_u32 v24, v24, 5, v63
    v_lshl_add_u32 v61, v24, 3, v162
    v_lshl_add_u32 v24, v24, 2, v163
    s_mov_b64 exec, s[72:73]
    ds_write_b32 v24, v60
    ds_write_b64 v61, v[152:153]
    s_mov_b64 exec, -1
    s_waitcnt lgkmcnt(11)
    v_lshl_add_u32 v25, v25, 5, v67
    v_lshl_add_u32 v65, v25, 3, v162
    v_lshl_add_u32 v25, v25, 2, v163
    s_mov_b64 exec, s[74:75]
    ds_write_b32 v25, v64
    ds_write_b64 v65, v[154:155]
    s_mov_b64 exec, -1
    s_waitcnt lgkmcnt(12)
    v_lshl_add_u32 v26, v26, 5, v71
    v_lshl_add_u32 v69, v26, 3, v162
    v_lshl_add_u32 v26, v26, 2, v163
    s_mov_b64 exec, s[76:77]
    ds_write_b32 v26, v68
    ds_write_b64 v69, v[156:157]
    s_mov_b64 exec, -1
    s_cmp_lg_u32 s89, 0
    s_cbranch_scc1 EB3_nopoll
    s_cmp_lg_u32 s3, 0
    s_cbranch_scc1 POLL_B_d
    s_mov_b32 s61, 0x100000
POLL_B_l:
    s_and_b32 s62, s2, 15
    s_lshl_b32 s62, s62, 10
    s_add_u32 s62, s62, 16384
    v_lshlrev_b32 v111, 4, v251
    buffer_load_dwordx4 v[112:115], v111, s[84:87], s62 offen sc1
    s_sub_u32 s61, s61, 1
    s_cbranch_scc1 POLL_B_d
    s_waitcnt vmcnt(0)
    v_xor_b32 v112, s96, v112
    v_xor_b32 v113, s96, v113
    v_xor_b32 v114, s96, v114
    v_xor_b32 v115, s96, v115
    v_or3_b32 v112, v112, v113, v114
    v_or_b32 v112, v112, v115
    v_cmp_ne_u32 vcc, 0, v112
    s_nop 0
    s_cmp_eq_u64 vcc, 0
    s_cbranch_scc1 POLL_B_d
    s_branch POLL_B_l
POLL_B_d:
EB3_nopoll:
    s_waitcnt lgkmcnt(0)
    s_barrier
    s_cmp_lg_u32 s89, 0
    s_cbranch_scc1 EB3_go
    s_mov_b32 m0, s57
    s_add_u32 s57, s57, 8192
    buffer_load_dwordx4 v128, s[8:11], 0 offen sc1 lds
    s_mov_b32 m0, s57
    s_add_u32 s57, s57, 8192
    buffer_load_dwordx4 v129, s[8:11], 0 offen sc1 lds
    s_mov_b32 m0, s57
    s_add_u32 s57, s57, 8192
    buffer_load_dwordx4 v130, s[8:11], 0 offen sc1 lds
    s_mov_b32 m0, s57
    s_add_u32 s57, s57, 8192
    buffer_load_dwordx4 v131, s[8:11], 0 offen sc1 lds
    s_mov_b32 m0, s57
    s_add_u32 s57, s57, 8192
    buffer_load_dwordx4 v132, s[8:11], 0 offen sc1 lds
    s_mov_b32 m0, s57
    s_add_u32 s57, s57, 8192
    buffer_load_dwordx4 v133, s[8:11], 0 offen sc1 lds
    s_mov_b32 m0, s57
    s_add_u32 s57, s57, 8192
    buffer_load_dwordx4 v134, s[8:11], 0 offen sc1 lds
    s_mov_b32 m0, s57
    s_add_u32 s57, s57, 8192
    buffer_load_dwordx4 v135, s[8:11], 0 offen sc1 lds
    s_mov_b32 m0, s57
    s_add_u32 s57, s57, 8192
    buffer_load_dwordx4 v136, s[8:11], 0 offen sc1 lds
    s_mov_b32 m0, s57
    s_add_u32 s57, s57, 8192
    buffer_load_dwordx4 v137, s[8:11], 0 offen sc1 lds
EB3_go:
    s_mov_b32 m0, s57
    s_add_u32 s57, s57, 8192
    buffer_load_dwordx4 v138, s[8:11], 0 offen sc1 lds
    s_mov_b32 m0, s57
    s_add_u32 s57, s57, 8192
    buffer_load_dwordx4 v139, s[8:11], 0 offen sc1 lds
    s_mov_b32 m0, s57
    s_add_u32 s57, s57, 8192
    buffer_load_dwordx4 v140, s[8:11], 0 offen sc1 lds
    s_cmp_ge_u32 s3, 2
    s_cbranch_scc1 NOE14
    s_mov_b32 m0, s57
    s_add_u32 s57, s57, 8192
    buffer_load_dwordx4 v141, s[8:11], 0 offen sc1 lds
NOE14:
    ds_read_b32 v188, v160 offset:0
    ds_read_b64 v[198:199], v161 offset:0
    ds_read_b32 v189, v160 offset:256
    ds_read_b64 v[200:201], v161 offset:512
    ds_read_b32 v190, v160 offset:512
    ds_read_b64 v[202:203], v161 offset:1024
    ds_read_b32 v191, v160 offset:768
    ds_read_b64 v[204:205], v161 offset:1536
    ds_read_b32 v192, v160 offset:1024
    ds_read_b64 v[206:207], v161 offset:2048
    ds_read_b32 v193, v160 offset:1280
    ds_read_b64 v[208:209], v161 offset:2560
    ds_read_b32 v194, v160 offset:1536
    ds_read_b64 v[210:211], v161 offset:3072
    ds_read_b32 v195, v160 offset:1792
    ds_read_b64 v[212:213], v161 offset:3584
    ds_read_b32 v196, v160 offset:2048
    ds_read_b64 v[214:215], v161 offset:4096
    ds_read_b32 v197, v160 offset:2304
    ds_read_b64 v[216:217], v161 offset:4608
    s_mov_b32 s45, 0
    s_mov_b32 s59, -2
    s_mov_b32 s48, 0
    s_mov_b32 s52, 0
    s_mov_b32 s49, 0
    s_mov_b32 s50, 128
    s_mov_b32 s47, s41
    v_readlane_b32 s46, v234, s47
    s_waitcnt lgkmcnt(0)
    s_barrier
    s_cmp_lg_u32 s42, 0
    s_cbranch_scc1 START
    s_waitcnt vmcnt(0)
    s_barrier
    s_branch TAIL
START:
    s_lshr_b32 s54, s45, 1
    s_set_gpr_idx_on s54, gpr_idx(SRC0)
    v_mov_b32 v223, v188
    s_set_gpr_idx_off
    s_nop 0
    v_mov_b32_dpp v223, v223 row_shr:4 row_mask:0xf bank_mask:0xa
    s_nop 1
    v_add_u32_dpp v224, v223, v228 quad_perm:[0,0,0,0] row_mask:0xf bank_mask:0xf
    v_add_u32_dpp v225, v223, v229 quad_perm:[1,1,1,1] row_mask:0xf bank_mask:0xf
    v_add_u32_dpp v226, v223, v228 quad_perm:[2,2,2,2] row_mask:0xf bank_mask:0xf
    v_add_u32_dpp v227, v223, v229 quad_perm:[3,3,3,3] row_mask:0xf bank_mask:0xf
    s_add_u32 m0, s51, 0
    s_nop 0
    buffer_load_dwordx4 v224, s[4:7], s49 offen sc1 lds
    buffer_load_dwordx4 v225, s[4:7], s49 offen offset:1088 sc1 lds
    s_add_u32 m0, s51, 2112
    s_nop 0
    buffer_load_dwordx4 v226, s[4:7], s49 offen sc1 lds
    buffer_load_dwordx4 v227, s[4:7], s49 offen offset:1088 sc1 lds
    s_add_u32 m0, s51, 4224
    s_nop 0
    buffer_load_dwordx4 v224, s[4:7], s50 offen sc1 lds
    buffer_load_dwordx4 v225, s[4:7], s50 offen offset:1088 sc1 lds
    s_set_gpr_idx_on s45, gpr_idx(SRC1)
    v_mad_u32_u16 v235, 8, v199, 0
    v_lshlrev_b32 v220, 16, v198
    v_and_b32 v221, s100, v198
    v_and_b32 v222, s100, v199
    s_set_gpr_idx_off
    v_add_u32_dpp v248, v235, v230 quad_perm:[0,0,0,0] row_mask:0xf bank_mask:0xf
    v_add_u32_dpp v249, v235, v230 quad_perm:[1,1,1,1] row_mask:0xf bank_mask:0xf
    s_waitcnt vmcnt(6)
    s_barrier
    ds_read_b64_tr_b16 v[160:161], v248
    ds_read_b64_tr_b16 v[162:163], v249
    s_waitcnt vmcnt(4)
    ds_read_b64_tr_b16 v[128:129], v231 offset:0
    ds_read_b64_tr_b16 v[132:133], v232 offset:32
    ds_read_b64_tr_b16 v[136:137], v231 offset:64
    ds_read_b64_tr_b16 v[140:141], v232 offset:96
    s_waitcnt lgkmcnt(0)
    s_add_u32 m0, s51, 0
    s_nop 0
    buffer_load_dwordx4 v226, s[4:7], s50 offen sc1 lds
    buffer_load_dwordx4 v227, s[4:7], s50 offen offset:1088 sc1 lds
    v_lshlrev_b32 v236, 16, v160
    v_and_b32 v237, s100, v160
    v_lshlrev_b32 v238, 16, v161
    v_and_b32 v239, s100, v161
    v_lshlrev_b32 v240, 16, v162
    v_and_b32 v241, s100, v162
    v_lshlrev_b32 v242, 16, v163
    v_and_b32 v243, s100, v163
    s_mov_b32 s45, 1
    s_cmp_lt_u32 s45, s44
    s_cbranch_scc0 I_w
    s_lshr_b32 s54, s45, 1
    s_set_gpr_idx_on s54, gpr_idx(SRC0)
    v_mov_b32 v223, v188
    s_set_gpr_idx_off
    s_nop 0
    v_mov_b32_dpp v223, v223 row_shl:4 row_mask:0xf bank_mask:0x5
    s_branch I_b
I_w:
    s_mov_b32 s45, 0
    s_add_u32 s49, s49, 3200000
    s_add_u32 s50, s50, 3200000
    s_lshr_b32 s54, s45, 1
    s_set_gpr_idx_on s54, gpr_idx(SRC0)
    v_mov_b32 v223, v188
    s_set_gpr_idx_off
    s_nop 0
    v_mov_b32_dpp v223, v223 row_shr:4 row_mask:0xf bank_mask:0xa
I_b:
    s_nop 1
    v_add_u32_dpp v224, v223, v228 quad_perm:[0,0,0,0] row_mask:0xf bank_mask:0xf
    v_add_u32_dpp v225, v223, v229 quad_perm:[1,1,1,1] row_mask:0xf bank_mask:0xf
    v_add_u32_dpp v226, v223, v228 quad_perm:[2,2,2,2] row_mask:0xf bank_mask:0xf
    v_add_u32_dpp v227, v223, v229 quad_perm:[3,3,3,3] row_mask:0xf bank_mask:0xf
    s_waitcnt vmcnt(4)
    ds_read_b64_tr_b16 v[130:131], v231 offset:2112
    ds_read_b64_tr_b16 v[134:135], v232 offset:2144
    ds_read_b64_tr_b16 v[138:139], v231 offset:2176
    ds_read_b64_tr_b16 v[142:143], v232 offset:2208
    v_mul_f32_dpp v244, v220, v236 row_newbcast:0 row_mask:0xf bank_mask:0xf
    v_mul_f32_dpp v245, v220, v237 row_newbcast:4 row_mask:0xf bank_mask:0xf
    v_cvt_pk_bf16_f32 v164, v244, v245
    v_mul_f32_dpp v246, v220, v238 row_newbcast:8 row_mask:0xf bank_mask:0xf
    v_mul_f32_dpp v247, v220, v239 row_newbcast:12 row_mask:0xf bank_mask:0xf
    v_cvt_pk_bf16_f32 v165, v246, v247
    v_mul_f32_dpp v244, v220, v240 row_newbcast:1 row_mask:0xf bank_mask:0xf
    v_mul_f32_dpp v245, v220, v241 row_newbcast:5 row_mask:0xf bank_mask:0xf
    v_cvt_pk_bf16_f32 v166, v244, v245
    v_mul_f32_dpp v246, v220, v242 row_newbcast:9 row_mask:0xf bank_mask:0xf
    v_mul_f32_dpp v247, v220, v243 row_newbcast:13 row_mask:0xf bank_mask:0xf
    v_cvt_pk_bf16_f32 v167, v246, v247
    v_mul_f32_dpp v244, v222, v236 row_newbcast:0 row_mask:0xf bank_mask:0xf
    v_mul_f32_dpp v245, v222, v237 row_newbcast:4 row_mask:0xf bank_mask:0xf
    v_cvt_pk_bf16_f32 v172, v244, v245
    v_mul_f32_dpp v246, v222, v238 row_newbcast:8 row_mask:0xf bank_mask:0xf
    v_mul_f32_dpp v247, v222, v239 row_newbcast:12 row_mask:0xf bank_mask:0xf
    v_cvt_pk_bf16_f32 v173, v246, v247
    s_waitcnt lgkmcnt(0)
    s_add_u32 m0, s51, 2112
    s_nop 0
    buffer_load_dwordx4 v224, s[4:7], s49 offen sc1 lds
    buffer_load_dwordx4 v225, s[4:7], s49 offen offset:1088 sc1 lds
    s_mov_b32 s57, 0
    v_lshlrev_b32 v67, 4, v251
    buffer_load_dwordx4 v[88:91], v67, s[24:27], s57 offen offset:0
    buffer_load_dwordx4 v[92:95], v67, s[24:27], s57 offen offset:1024
    buffer_load_dwordx4 v[96:99], v67, s[24:27], s57 offen offset:2048
    buffer_load_dwordx4 v[100:103], v67, s[24:27], s57 offen offset:3072
    s_add_u32 s57, s57, 4096
    buffer_load_dwordx4 v[104:107], v67, s[24:27], s57 offen offset:0
    buffer_load_dwordx4 v[108:111], v67, s[24:27], s57 offen offset:1024
    buffer_load_dwordx4 v[112:115], v67, s[24:27], s57 offen offset:2048
    buffer_load_dwordx4 v[116:119], v67, s[24:27], s57 offen offset:3072
    s_add_u32 s57, s57, 4096
    buffer_load_dwordx4 v[120:123], v67, s[24:27], s57 offen offset:0
    buffer_load_dwordx4 v[124:127], v67, s[24:27], s57 offen offset:1024
    s_mov_b32 s58, 11
    s_cmp_eq_u32 s42, 7
    s_cmov_b32 s58, 43
    s_cmp_ge_u32 s3, 4
    s_cmov_b32 s58, -1
    s_setprio 2
    s_cmp_lt_u32 s3, 4
    s_cbranch_scc1 I_p
    s_setprio 1
I_p:
    s_cmp_eq_u32 s45, 0
    s_cbranch_scc1 S0f00
    s_branch S0f01
EP00:
    s_setprio 0
    v_mul_f32 v16, v16, v104
    v_mul_f32 v20, v20, v108
    v_fmac_f32 v16, v17, v105
    v_fmac_f32 v20, v21, v109
    v_fmac_f32 v16, v18, v106
    v_fmac_f32 v20, v22, v110
    v_fmac_f32 v16, v19, v107
    v_fmac_f32 v20, v23, v111
    v_cvt_pk_bf16_f32 v146, v16, v20
    v_mul_f32 v0, v0, v88
    v_mul_f32 v4, v4, v92
    v_fmac_f32 v0, v1, v89
    v_fmac_f32 v4, v5, v93
    v_fmac_f32 v0, v2, v90
    v_fmac_f32 v4, v6, v94
    v_fmac_f32 v0, v3, v91
    v_fmac_f32 v4, v7, v95
    v_cvt_pk_bf16_f32 v144, v0, v4
    v_mov_b32 v155, 0
    v_mul_f32 v40, v40, v112
    v_mul_f32 v44, v44, v116
    v_fmac_f32 v40, v41, v113
    v_fmac_f32 v44, v45, v117
    v_fmac_f32 v40, v42, v114
    v_fmac_f32 v44, v46, v118
    v_fmac_f32 v40, v43, v115
    v_fmac_f32 v44, v47, v119
    v_cvt_pk_bf16_f32 v149, v40, v44
    v_mul_f32 v32, v32, v104
    v_mul_f32 v36, v36, v108
    v_fmac_f32 v32, v33, v105
    v_fmac_f32 v36, v37, v109
    v_fmac_f32 v32, v34, v106
    v_fmac_f32 v36, v38, v110
    v_fmac_f32 v32, v35, v107
    v_fmac_f32 v36, v39, v111
    v_cvt_pk_bf16_f32 v148, v32, v36
    v_mul_f32 v24, v24, v104
    v_mul_f32 v28, v28, v108
    v_fmac_f32 v24, v25, v105
    v_fmac_f32 v28, v29, v109
    v_fmac_f32 v24, v26, v106
    v_fmac_f32 v28, v30, v110
    v_fmac_f32 v24, v27, v107
    v_fmac_f32 v28, v31, v111
    v_cvt_pk_bf16_f32 v147, v24, v28
    v_mul_f32 v80, v80, v120
    v_mul_f32 v84, v84, v124
    v_fmac_f32 v80, v81, v121
    v_fmac_f32 v84, v85, v125
    v_fmac_f32 v80, v82, v122
    v_fmac_f32 v84, v86, v126
    v_fmac_f32 v80, v83, v123
    v_fmac_f32 v84, v87, v127
    v_cvt_pk_bf16_f32 v154, -v80, -v84
    v_mul_f32 v72, v72, v120
    v_mul_f32 v76, v76, v124
    v_fmac_f32 v72, v73, v121
    v_fmac_f32 v76, v77, v125
    v_fmac_f32 v72, v74, v122
    v_fmac_f32 v76, v78, v126
    v_fmac_f32 v72, v75, v123
    v_fmac_f32 v76, v79, v127
    v_cvt_pk_bf16_f32 v153, v72, v76
    v_mul_f32 v48, v48, v112
    v_mul_f32 v52, v52, v116
    v_fmac_f32 v48, v49, v113
    v_fmac_f32 v52, v53, v117
    v_fmac_f32 v48, v50, v114
    v_fmac_f32 v52, v54, v118
    v_fmac_f32 v48, v51, v115
    v_fmac_f32 v52, v55, v119
    v_cvt_pk_bf16_f32 v150, v48, v52
    v_mul_f32 v56, v56, v112
    v_mul_f32 v60, v60, v116
    v_fmac_f32 v56, v57, v113
    v_fmac_f32 v60, v61, v117
    v_fmac_f32 v56, v58, v114
    v_fmac_f32 v60, v62, v118
    v_fmac_f32 v56, v59, v115
    v_fmac_f32 v60, v63, v119
    v_cvt_pk_bf16_f32 v151, v56, v60
    v_mul_f32 v8, v8, v96
    v_mul_f32 v12, v12, v100
    v_fmac_f32 v8, v9, v97
    v_fmac_f32 v12, v13, v101
    v_fmac_f32 v8, v10, v98
    v_fmac_f32 v12, v14, v102
    v_fmac_f32 v8, v11, v99
    v_fmac_f32 v12, v15, v103
    v_cvt_pk_bf16_f32 v145, v8, v12
    v_mfma_f32_16x16x32_bf16 v[20:23], v[184:187], v[148:151], 0
    v_mul_f32 v64, v64, v120
    v_mul_f32 v68, v68, v124
    v_fmac_f32 v64, v65, v121
    v_fmac_f32 v68, v69, v125
    v_fmac_f32 v64, v66, v122
    v_fmac_f32 v68, v70, v126
    v_fmac_f32 v64, v67, v123
    v_fmac_f32 v68, v71, v127
    v_cvt_pk_bf16_f32 v152, v64, v68
    s_ashr_i32 s58, s58, 1
    s_bitcmp1_b32 s58, 0
    s_cbranch_scc0 EP00_p
    s_setprio 1
EP00_p:
    s_mul_i32 s55, s47, 784
    v_mfma_f32_16x16x32_bf16 v[16:19], v[184:187], v[144:147], 0
    v_mfma_f32_16x16x32_bf16 v[24:27], v[184:187], v[152:155], 0
    v_cvt_pk_bf16_f32 v65, v20, v21
    s_add_u32 s55, s55, s52
    s_add_u32 s47, s47, 1
    s_cmp_lt_u32 s47, s79
    s_cselect_b32 s56, s47, -2
    s_cselect_b32 s47, s47, s41
    v_readlane_b32 s46, v234, s47
    s_cmp_ge_u32 s56, s59
    buffer_store_dword v65, v233, s[20:23], s55 offen offset:256
    v_cvt_pk_bf16_f32 v64, v16, v17
    v_cvt_pk_bf16_f32 v66, v24, v25
    buffer_store_dword v64, v233, s[20:23], s55 offen offset:0
    buffer_store_dword v66, v233, s[20:23], s55 offen offset:512
    s_cbranch_scc1 EP00_evt
EP00_go:
    s_cmp_eq_u32 s45, 0
    s_cbranch_scc1 S0f00
S0f01:
    v_mfma_f32_16x16x32_bf16 v[16:19], v[164:167], v[128:131], 0
    v_mul_f32_dpp v244, v222, v240 row_newbcast:1 row_mask:0xf bank_mask:0xf
    v_mul_f32_dpp v245, v222, v241 row_newbcast:5 row_mask:0xf bank_mask:0xf
    s_waitcnt vmcnt(7)
    ds_read_b64_tr_b16 v[144:145], v231 offset:4224
    ds_read_b64_tr_b16 v[148:149], v232 offset:4256
    ds_read_b64_tr_b16 v[152:153], v231 offset:4288
    ds_read_b64_tr_b16 v[156:157], v232 offset:4320
    v_mfma_f32_16x16x32_bf16 v[20:23], v[164:167], v[132:135], 0
    v_cvt_pk_bf16_f32 v174, v244, v245
    v_mul_f32_dpp v246, v222, v242 row_newbcast:9 row_mask:0xf bank_mask:0xf
    s_add_u32 m0, s51, 4224
    v_mfma_f32_16x16x32_bf16 v[8:11], v[164:167], v[136:139], 0
    v_mul_f32_dpp v247, v222, v243 row_newbcast:13 row_mask:0xf bank_mask:0xf
    v_cvt_pk_bf16_f32 v175, v246, v247
    s_waitcnt lgkmcnt(0)
    buffer_load_dwordx4 v226, s[4:7], s49 offen sc1 lds
    buffer_load_dwordx4 v227, s[4:7], s49 offen offset:1088 sc1 lds
    v_mfma_f32_16x16x32_bf16 v[12:15], v[164:167], v[140:143], 0
    v_mul_f32_dpp v244, v221, v236 row_newbcast:0 row_mask:0xf bank_mask:0xf
    v_mul_f32_dpp v245, v221, v237 row_newbcast:4 row_mask:0xf bank_mask:0xf
    v_mfma_f32_16x16x32_bf16 v[0:3], v[160:163], v[128:131], 0
    v_cvt_pk_bf16_f32 v168, v244, v245
    v_mfma_f32_16x16x32_bf16 v[4:7], v[160:163], v[132:135], 0
    v_mul_f32_dpp v246, v221, v238 row_newbcast:8 row_mask:0xf bank_mask:0xf
    v_mul_f32_dpp v247, v221, v239 row_newbcast:12 row_mask:0xf bank_mask:0xf
    v_mfma_f32_16x16x32_bf16 v[40:43], v[160:163], v[136:139], 0
    v_cvt_pk_bf16_f32 v169, v246, v247
    v_mul_f32_dpp v244, v221, v240 row_newbcast:1 row_mask:0xf bank_mask:0xf
    v_mfma_f32_16x16x32_bf16 v[44:47], v[160:163], v[140:143], 0
    v_mul_f32_dpp v245, v221, v241 row_newbcast:5 row_mask:0xf bank_mask:0xf
    v_cvt_pk_bf16_f32 v170, v244, v245
    v_mfma_f32_16x16x32_bf16 v[32:35], v[172:175], v[128:131], 0
    v_mul_f32_dpp v246, v221, v242 row_newbcast:9 row_mask:0xf bank_mask:0xf
    v_mul_f32_dpp v247, v221, v243 row_newbcast:13 row_mask:0xf bank_mask:0xf
    s_waitcnt vmcnt(7)
    ds_read_b64_tr_b16 v[146:147], v231 offset:0
    ds_read_b64_tr_b16 v[150:151], v232 offset:32
    ds_read_b64_tr_b16 v[154:155], v231 offset:64
    ds_read_b64_tr_b16 v[158:159], v232 offset:96
    v_mfma_f32_16x16x32_bf16 v[36:39], v[172:175], v[132:135], 0
    v_cvt_pk_bf16_f32 v171, v246, v247
    v_xor_b32 v176, s101, v164
    s_add_u32 m0, s51, 0
    v_mfma_f32_16x16x32_bf16 v[72:75], v[172:175], v[136:139], 0
    v_xor_b32 v177, s101, v165
    v_add_u32_dpp v248, v235, v230 quad_perm:[2,2,2,2] row_mask:0xf bank_mask:0xf
    s_waitcnt lgkmcnt(0)
    buffer_load_dwordx4 v224, s[4:7], s50 offen sc1 lds
    buffer_load_dwordx4 v225, s[4:7], s50 offen offset:1088 sc1 lds
    v_mfma_f32_16x16x32_bf16 v[76:79], v[172:175], v[140:143], 0
    v_add_u32_dpp v249, v235, v230 quad_perm:[3,3,3,3] row_mask:0xf bank_mask:0xf
    ds_read_b64_tr_b16 v[252:253], v248
    ds_read_b64_tr_b16 v[254:255], v249
    v_xor_b32 v178, s101, v166
    v_mfma_f32_16x16x32_bf16 v[24:27], v[168:171], v[128:131], 0
    v_xor_b32 v179, s101, v167
    v_mfma_f32_16x16x32_bf16 v[28:31], v[168:171], v[132:135], 0
    v_xor_b32 v180, s101, v172
    v_xor_b32 v181, s101, v173
    v_mfma_f32_16x16x32_bf16 v[80:83], v[168:171], v[136:139], 0
    v_xor_b32 v182, s101, v174
    v_xor_b32 v183, s101, v175
    v_mfma_f32_16x16x32_bf16 v[84:87], v[168:171], v[140:143], 0
    s_waitcnt lgkmcnt(0)
    v_lshlrev_b32 v236, 16, v252
    v_and_b32 v237, s100, v252
    v_mfma_f32_16x16x32_bf16 v[84:87], v[176:179], v[148:151], v[84:87]
    v_lshlrev_b32 v238, 16, v253
    v_and_b32 v239, s100, v253
    s_waitcnt vmcnt(7)
    ds_read_b64_tr_b16 v[128:129], v231 offset:2112
    ds_read_b64_tr_b16 v[132:133], v232 offset:2144
    ds_read_b64_tr_b16 v[136:137], v231 offset:2176
    ds_read_b64_tr_b16 v[140:141], v232 offset:2208
    v_mfma_f32_16x16x32_bf16 v[80:83], v[176:179], v[144:147], v[80:83]
    v_lshlrev_b32 v240, 16, v254
    v_and_b32 v241, s100, v254
    s_add_u32 m0, s51, 2112
    v_mfma_f32_16x16x32_bf16 v[72:75], v[176:179], v[152:155], v[72:75]
    v_lshlrev_b32 v242, 16, v255
    v_and_b32 v243, s100, v255
    s_waitcnt lgkmcnt(0)
    buffer_load_dwordx4 v226, s[4:7], s50 offen sc1 lds
    buffer_load_dwordx4 v227, s[4:7], s50 offen offset:1088 sc1 lds
    v_mfma_f32_16x16x32_bf16 v[76:79], v[176:179], v[156:159], v[76:79]
    v_mul_f32_dpp v244, v220, v236 row_newbcast:2 row_mask:0xf bank_mask:0xf
    v_mul_f32_dpp v245, v220, v237 row_newbcast:6 row_mask:0xf bank_mask:0xf
    v_mfma_f32_16x16x32_bf16 v[48:51], v[160:163], v[144:147], 0
    v_cvt_pk_bf16_f32 v164, v244, v245
    v_mfma_f32_16x16x32_bf16 v[52:55], v[160:163], v[148:151], 0
    s_add_u32 s45, s45, 1
    s_cmp_lt_u32 s45, s44
    s_cbranch_scc0 S0f01_w
S0f01_b:
    s_lshr_b32 s54, s45, 1
    s_set_gpr_idx_on s54, gpr_idx(SRC0)
    v_mov_b32 v223, v188
    s_set_gpr_idx_off
    v_mul_f32_dpp v246, v220, v238 row_newbcast:10 row_mask:0xf bank_mask:0xf
    v_mfma_f32_16x16x32_bf16 v[56:59], v[160:163], v[152:155], 0
    v_mov_b32_dpp v223, v223 row_shr:4 row_mask:0xf bank_mask:0xa
    v_mul_f32_dpp v247, v220, v239 row_newbcast:14 row_mask:0xf bank_mask:0xf
    v_mfma_f32_16x16x32_bf16 v[60:63], v[160:163], v[156:159], 0
    v_cvt_pk_bf16_f32 v165, v246, v247
    v_add_u32_dpp v224, v223, v228 quad_perm:[0,0,0,0] row_mask:0xf bank_mask:0xf
    v_mfma_f32_16x16x32_bf16 v[8:11], v[168:171], v[144:147], v[8:11]
    v_add_u32_dpp v225, v223, v229 quad_perm:[1,1,1,1] row_mask:0xf bank_mask:0xf
    v_mul_f32_dpp v244, v220, v240 row_newbcast:3 row_mask:0xf bank_mask:0xf
    s_waitcnt vmcnt(4)
    ds_read_b64_tr_b16 v[130:131], v231 offset:4224
    ds_read_b64_tr_b16 v[134:135], v232 offset:4256
    ds_read_b64_tr_b16 v[138:139], v231 offset:4288
    ds_read_b64_tr_b16 v[142:143], v232 offset:4320
    v_mfma_f32_16x16x32_bf16 v[8:11], v[172:175], v[152:155], v[8:11]
    v_mul_f32_dpp v245, v220, v241 row_newbcast:7 row_mask:0xf bank_mask:0xf
    v_cvt_pk_bf16_f32 v166, v244, v245
    s_add_u32 m0, s51, 4224
    v_mfma_f32_16x16x32_bf16 v[12:15], v[168:171], v[148:151], v[12:15]
    v_mul_f32_dpp v246, v220, v242 row_newbcast:11 row_mask:0xf bank_mask:0xf
    v_mul_f32_dpp v247, v220, v243 row_newbcast:15 row_mask:0xf bank_mask:0xf
    s_waitcnt lgkmcnt(0)
    buffer_load_dwordx4 v224, s[4:7], s49 offen sc1 lds
    buffer_load_dwordx4 v225, s[4:7], s49 offen offset:1088 sc1 lds
    v_mfma_f32_16x16x32_bf16 v[12:15], v[172:175], v[156:159], v[12:15]
    v_cvt_pk_bf16_f32 v167, v246, v247
    v_add_u32_dpp v226, v223, v228 quad_perm:[2,2,2,2] row_mask:0xf bank_mask:0xf
    v_mfma_f32_16x16x32_bf16 v[64:67], v[180:183], v[144:147], 0
    v_add_u32_dpp v227, v223, v229 quad_perm:[3,3,3,3] row_mask:0xf bank_mask:0xf
    v_mfma_f32_16x16x32_bf16 v[64:67], v[168:171], v[152:155], v[64:67]
    v_mul_f32_dpp v244, v222, v236 row_newbcast:2 row_mask:0xf bank_mask:0xf
    v_mul_f32_dpp v245, v222, v237 row_newbcast:6 row_mask:0xf bank_mask:0xf
    v_mfma_f32_16x16x32_bf16 v[68:71], v[180:183], v[148:151], 0
    v_cvt_pk_bf16_f32 v172, v244, v245
    v_mul_f32_dpp v246, v222, v238 row_newbcast:10 row_mask:0xf bank_mask:0xf
    v_mfma_f32_16x16x32_bf16 v[68:71], v[168:171], v[156:159], v[68:71]
    v_mul_f32_dpp v247, v222, v239 row_newbcast:14 row_mask:0xf bank_mask:0xf
    v_cvt_pk_bf16_f32 v173, v246, v247
    s_sub_u32 s46, s46, 1
    s_cbranch_scc1 EP11
S1n10:
    v_mfma_f32_16x16x32_bf16 v[16:19], v[164:167], v[128:131], v[16:19]
    v_mul_f32_dpp v244, v222, v240 row_newbcast:3 row_mask:0xf bank_mask:0xf
    v_mul_f32_dpp v245, v222, v241 row_newbcast:7 row_mask:0xf bank_mask:0xf
    s_waitcnt vmcnt(4)
    ds_read_b64_tr_b16 v[144:145], v231 offset:0
    ds_read_b64_tr_b16 v[148:149], v232 offset:32
    ds_read_b64_tr_b16 v[152:153], v231 offset:64
    ds_read_b64_tr_b16 v[156:157], v232 offset:96
    v_mfma_f32_16x16x32_bf16 v[20:23], v[164:167], v[132:135], v[20:23]
    v_cvt_pk_bf16_f32 v174, v244, v245
    v_mul_f32_dpp v246, v222, v242 row_newbcast:11 row_mask:0xf bank_mask:0xf
    s_add_u32 m0, s51, 0
    v_mfma_f32_16x16x32_bf16 v[8:11], v[164:167], v[136:139], v[8:11]
    v_mul_f32_dpp v247, v222, v243 row_newbcast:15 row_mask:0xf bank_mask:0xf
    v_cvt_pk_bf16_f32 v175, v246, v247
    s_waitcnt lgkmcnt(0)
    buffer_load_dwordx4 v226, s[4:7], s49 offen sc1 lds
    buffer_load_dwordx4 v227, s[4:7], s49 offen offset:1088 sc1 lds
    v_mfma_f32_16x16x32_bf16 v[12:15], v[164:167], v[140:143], v[12:15]
    v_mul_f32_dpp v244, v221, v236 row_newbcast:2 row_mask:0xf bank_mask:0xf
    v_mul_f32_dpp v245, v221, v237 row_newbcast:6 row_mask:0xf bank_mask:0xf
    v_mfma_f32_16x16x32_bf16 v[0:3], v[252:255], v[128:131], v[0:3]
    v_cvt_pk_bf16_f32 v168, v244, v245
    v_mul_f32_dpp v246, v221, v238 row_newbcast:10 row_mask:0xf bank_mask:0xf
    v_mfma_f32_16x16x32_bf16 v[4:7], v[252:255], v[132:135], v[4:7]
    v_mul_f32_dpp v247, v221, v239 row_newbcast:14 row_mask:0xf bank_mask:0xf
    v_cvt_pk_bf16_f32 v169, v246, v247
    v_mfma_f32_16x16x32_bf16 v[40:43], v[252:255], v[136:139], v[40:43]
    v_mul_f32_dpp v244, v221, v240 row_newbcast:3 row_mask:0xf bank_mask:0xf
    v_mul_f32_dpp v245, v221, v241 row_newbcast:7 row_mask:0xf bank_mask:0xf
    v_mfma_f32_16x16x32_bf16 v[44:47], v[252:255], v[140:143], v[44:47]
    v_cvt_pk_bf16_f32 v170, v244, v245
    v_mul_f32_dpp v246, v221, v242 row_newbcast:11 row_mask:0xf bank_mask:0xf
    v_mfma_f32_16x16x32_bf16 v[32:35], v[172:175], v[128:131], v[32:35]
    v_mul_f32_dpp v247, v221, v243 row_newbcast:15 row_mask:0xf bank_mask:0xf
    v_cvt_pk_bf16_f32 v171, v246, v247
    s_waitcnt vmcnt(4)
    ds_read_b64_tr_b16 v[146:147], v231 offset:2112
    ds_read_b64_tr_b16 v[150:151], v232 offset:2144
    ds_read_b64_tr_b16 v[154:155], v231 offset:2176
    ds_read_b64_tr_b16 v[158:159], v232 offset:2208
    v_mfma_f32_16x16x32_bf16 v[36:39], v[172:175], v[132:135], v[36:39]
    s_set_gpr_idx_on s45, gpr_idx(SRC1)
    v_mad_u32_u16 v235, 8, v199, 0
    v_lshlrev_b32 v220, 16, v198
    v_and_b32 v221, s100, v198
    v_and_b32 v222, s100, v199
    s_set_gpr_idx_off
    s_add_u32 m0, s51, 2112
    v_mfma_f32_16x16x32_bf16 v[72:75], v[172:175], v[136:139], v[72:75]
    s_waitcnt lgkmcnt(0)
    buffer_load_dwordx4 v224, s[4:7], s50 offen sc1 lds
    buffer_load_dwordx4 v225, s[4:7], s50 offen offset:1088 sc1 lds
    v_mfma_f32_16x16x32_bf16 v[76:79], v[172:175], v[140:143], v[76:79]
    v_xor_b32 v176, s101, v164
    v_xor_b32 v177, s101, v165
    v_mfma_f32_16x16x32_bf16 v[24:27], v[168:171], v[128:131], v[24:27]
    v_add_u32_dpp v248, v235, v230 quad_perm:[0,0,0,0] row_mask:0xf bank_mask:0xf
    v_add_u32_dpp v249, v235, v230 quad_perm:[1,1,1,1] row_mask:0xf bank_mask:0xf
    ds_read_b64_tr_b16 v[160:161], v248
    ds_read_b64_tr_b16 v[162:163], v249
    v_mfma_f32_16x16x32_bf16 v[28:31], v[168:171], v[132:135], v[28:31]
    v_xor_b32 v178, s101, v166
    v_xor_b32 v179, s101, v167
    v_mfma_f32_16x16x32_bf16 v[80:83], v[168:171], v[136:139], v[80:83]
    v_xor_b32 v180, s101, v172
    v_xor_b32 v181, s101, v173
    v_mfma_f32_16x16x32_bf16 v[84:87], v[168:171], v[140:143], v[84:87]
    v_xor_b32 v182, s101, v174
    v_xor_b32 v183, s101, v175
    v_mfma_f32_16x16x32_bf16 v[84:87], v[176:179], v[148:151], v[84:87]
    s_waitcnt lgkmcnt(0)
    v_lshlrev_b32 v236, 16, v160
    v_and_b32 v237, s100, v160
    s_waitcnt vmcnt(4)
    ds_read_b64_tr_b16 v[128:129], v231 offset:4224
    ds_read_b64_tr_b16 v[132:133], v232 offset:4256
    ds_read_b64_tr_b16 v[136:137], v231 offset:4288
    ds_read_b64_tr_b16 v[140:141], v232 offset:4320
    v_mfma_f32_16x16x32_bf16 v[80:83], v[176:179], v[144:147], v[80:83]
    v_lshlrev_b32 v238, 16, v161
    v_and_b32 v239, s100, v161
    s_add_u32 m0, s51, 4224
    v_mfma_f32_16x16x32_bf16 v[72:75], v[176:179], v[152:155], v[72:75]
    v_lshlrev_b32 v240, 16, v162
    v_and_b32 v241, s100, v162
    s_waitcnt lgkmcnt(0)
    buffer_load_dwordx4 v226, s[4:7], s50 offen sc1 lds
    buffer_load_dwordx4 v227, s[4:7], s50 offen offset:1088 sc1 lds
    v_mfma_f32_16x16x32_bf16 v[76:79], v[176:179], v[156:159], v[76:79]
    v_lshlrev_b32 v242, 16, v163
    v_and_b32 v243, s100, v163
    v_mfma_f32_16x16x32_bf16 v[48:51], v[252:255], v[144:147], v[48:51]
    v_mul_f32_dpp v244, v220, v236 row_newbcast:0 row_mask:0xf bank_mask:0xf
    v_mul_f32_dpp v245, v220, v237 row_newbcast:4 row_mask:0xf bank_mask:0xf
    v_mfma_f32_16x16x32_bf16 v[52:55], v[252:255], v[148:151], v[52:55]
    v_cvt_pk_bf16_f32 v164, v244, v245
    v_mfma_f32_16x16x32_bf16 v[56:59], v[252:255], v[152:155], v[56:59]
    s_add_u32 s45, s45, 1
    s_cmp_lt_u32 s45, s44
    s_cbranch_scc0 S1n10_w
    s_lshr_b32 s54, s45, 1
    s_set_gpr_idx_on s54, gpr_idx(SRC0)
    v_mov_b32 v223, v188
    s_set_gpr_idx_off
    v_mul_f32_dpp v246, v220, v238 row_newbcast:8 row_mask:0xf bank_mask:0xf
    v_mov_b32_dpp v223, v223 row_shl:4 row_mask:0xf bank_mask:0x5
S1n10_b:
    v_mfma_f32_16x16x32_bf16 v[60:63], v[252:255], v[156:159], v[60:63]
    v_mul_f32_dpp v247, v220, v239 row_newbcast:12 row_mask:0xf bank_mask:0xf
    v_cvt_pk_bf16_f32 v165, v246, v247
    v_mfma_f32_16x16x32_bf16 v[8:11], v[168:171], v[144:147], v[8:11]
    v_add_u32_dpp v224, v223, v228 quad_perm:[0,0,0,0] row_mask:0xf bank_mask:0xf
    v_add_u32_dpp v225, v223, v229 quad_perm:[1,1,1,1] row_mask:0xf bank_mask:0xf
    s_waitcnt vmcnt(4)
    ds_read_b64_tr_b16 v[130:131], v231 offset:0
    ds_read_b64_tr_b16 v[134:135], v232 offset:32
    ds_read_b64_tr_b16 v[138:139], v231 offset:64
    ds_read_b64_tr_b16 v[142:143], v232 offset:96
    v_mfma_f32_16x16x32_bf16 v[8:11], v[172:175], v[152:155], v[8:11]
    v_mul_f32_dpp v244, v220, v240 row_newbcast:1 row_mask:0xf bank_mask:0xf
    v_mul_f32_dpp v245, v220, v241 row_newbcast:5 row_mask:0xf bank_mask:0xf
    s_add_u32 m0, s51, 0
    v_mfma_f32_16x16x32_bf16 v[12:15], v[168:171], v[148:151], v[12:15]
    v_cvt_pk_bf16_f32 v166, v244, v245
    v_mul_f32_dpp v246, v220, v242 row_newbcast:9 row_mask:0xf bank_mask:0xf
    s_waitcnt lgkmcnt(0)
    buffer_load_dwordx4 v224, s[4:7], s49 offen sc1 lds
    buffer_load_dwordx4 v225, s[4:7], s49 offen offset:1088 sc1 lds
    v_mfma_f32_16x16x32_bf16 v[12:15], v[172:175], v[156:159], v[12:15]
    v_mul_f32_dpp v247, v220, v243 row_newbcast:13 row_mask:0xf bank_mask:0xf
    v_cvt_pk_bf16_f32 v167, v246, v247
    v_mfma_f32_16x16x32_bf16 v[64:67], v[180:183], v[144:147], v[64:67]
    v_add_u32_dpp v226, v223, v228 quad_perm:[2,2,2,2] row_mask:0xf bank_mask:0xf
    v_add_u32_dpp v227, v223, v229 quad_perm:[3,3,3,3] row_mask:0xf bank_mask:0xf
    v_mfma_f32_16x16x32_bf16 v[64:67], v[168:171], v[152:155], v[64:67]
    v_mul_f32_dpp v244, v222, v236 row_newbcast:0 row_mask:0xf bank_mask:0xf
    v_mul_f32_dpp v245, v222, v237 row_newbcast:4 row_mask:0xf bank_mask:0xf
    v_mfma_f32_16x16x32_bf16 v[68:71], v[180:183], v[148:151], v[68:71]
    v_cvt_pk_bf16_f32 v172, v244, v245
    v_mul_f32_dpp v246, v222, v238 row_newbcast:8 row_mask:0xf bank_mask:0xf
    v_mfma_f32_16x16x32_bf16 v[68:71], v[168:171], v[156:159], v[68:71]
    v_mul_f32_dpp v247, v222, v239 row_newbcast:12 row_mask:0xf bank_mask:0xf
    v_cvt_pk_bf16_f32 v173, v246, v247
    s_sub_u32 s46, s46, 1
    s_cbranch_scc0 S1n10_c
EP20:
    s_setprio 0
    v_mul_f32 v16, v16, v104
    v_mul_f32 v20, v20, v108
    v_fmac_f32 v16, v17, v105
    v_fmac_f32 v20, v21, v109
    v_fmac_f32 v16, v18, v106
    v_fmac_f32 v20, v22, v110
    v_fmac_f32 v16, v19, v107
    v_fmac_f32 v20, v23, v111
    v_cvt_pk_bf16_f32 v146, v16, v20
    v_mul_f32 v0, v0, v88
    v_mul_f32 v4, v4, v92
    v_fmac_f32 v0, v1, v89
    v_fmac_f32 v4, v5, v93
    v_fmac_f32 v0, v2, v90
    v_fmac_f32 v4, v6, v94
    v_fmac_f32 v0, v3, v91
    v_fmac_f32 v4, v7, v95
    v_cvt_pk_bf16_f32 v144, v0, v4
    v_mov_b32 v155, 0
    v_mul_f32 v40, v40, v112
    v_mul_f32 v44, v44, v116
    v_fmac_f32 v40, v41, v113
    v_fmac_f32 v44, v45, v117
    v_fmac_f32 v40, v42, v114
    v_fmac_f32 v44, v46, v118
    v_fmac_f32 v40, v43, v115
    v_fmac_f32 v44, v47, v119
    v_cvt_pk_bf16_f32 v149, v40, v44
    v_mul_f32 v32, v32, v104
    v_mul_f32 v36, v36, v108
    v_fmac_f32 v32, v33, v105
    v_fmac_f32 v36, v37, v109
    v_fmac_f32 v32, v34, v106
    v_fmac_f32 v36, v38, v110
    v_fmac_f32 v32, v35, v107
    v_fmac_f32 v36, v39, v111
    v_cvt_pk_bf16_f32 v148, v32, v36
    v_mul_f32 v24, v24, v104
    v_mul_f32 v28, v28, v108
    v_fmac_f32 v24, v25, v105
    v_fmac_f32 v28, v29, v109
    v_fmac_f32 v24, v26, v106
    v_fmac_f32 v28, v30, v110
    v_fmac_f32 v24, v27, v107
    v_fmac_f32 v28, v31, v111
    v_cvt_pk_bf16_f32 v147, v24, v28
    v_mul_f32 v80, v80, v120
    v_mul_f32 v84, v84, v124
    v_fmac_f32 v80, v81, v121
    v_fmac_f32 v84, v85, v125
    v_fmac_f32 v80, v82, v122
    v_fmac_f32 v84, v86, v126
    v_fmac_f32 v80, v83, v123
    v_fmac_f32 v84, v87, v127
    v_cvt_pk_bf16_f32 v154, -v80, -v84
    v_mul_f32 v72, v72, v120
    v_mul_f32 v76, v76, v124
    v_fmac_f32 v72, v73, v121
    v_fmac_f32 v76, v77, v125
    v_fmac_f32 v72, v74, v122
    v_fmac_f32 v76, v78, v126
    v_fmac_f32 v72, v75, v123
    v_fmac_f32 v76, v79, v127
    v_cvt_pk_bf16_f32 v153, v72, v76
    v_mul_f32 v48, v48, v112
    v_mul_f32 v52, v52, v116
    v_fmac_f32 v48, v49, v113
    v_fmac_f32 v52, v53, v117
    v_fmac_f32 v48, v50, v114
    v_fmac_f32 v52, v54, v118
    v_fmac_f32 v48, v51, v115
    v_fmac_f32 v52, v55, v119
    v_cvt_pk_bf16_f32 v150, v48, v52
    v_mul_f32 v56, v56, v112
    v_mul_f32 v60, v60, v116
    v_fmac_f32 v56, v57, v113
    v_fmac_f32 v60, v61, v117
    v_fmac_f32 v56, v58, v114
    v_fmac_f32 v60, v62, v118
    v_fmac_f32 v56, v59, v115
    v_fmac_f32 v60, v63, v119
    v_cvt_pk_bf16_f32 v151, v56, v60
    v_mul_f32 v8, v8, v96
    v_mul_f32 v12, v12, v100
    v_fmac_f32 v8, v9, v97
    v_fmac_f32 v12, v13, v101
    v_fmac_f32 v8, v10, v98
    v_fmac_f32 v12, v14, v102
    v_fmac_f32 v8, v11, v99
    v_fmac_f32 v12, v15, v103
    v_cvt_pk_bf16_f32 v145, v8, v12
    v_mfma_f32_16x16x32_bf16 v[20:23], v[184:187], v[148:151], 0
    v_mul_f32 v64, v64, v120
    v_mul_f32 v68, v68, v124
    v_fmac_f32 v64, v65, v121
    v_fmac_f32 v68, v69, v125
    v_fmac_f32 v64, v66, v122
    v_fmac_f32 v68, v70, v126
    v_fmac_f32 v64, v67, v123
    v_fmac_f32 v68, v71, v127
    v_cvt_pk_bf16_f32 v152, v64, v68
    s_ashr_i32 s58, s58, 1
    s_bitcmp1_b32 s58, 0
    s_cbranch_scc0 EP20_p
    s_setprio 1
EP20_p:
    s_mul_i32 s55, s47, 784
    v_mfma_f32_16x16x32_bf16 v[16:19], v[184:187], v[144:147], 0
    v_mfma_f32_16x16x32_bf16 v[24:27], v[184:187], v[152:155], 0
    v_cvt_pk_bf16_f32 v65, v20, v21
    s_add_u32 s55, s55, s52
    s_add_u32 s47, s47, 1
    s_cmp_lt_u32 s47, s79
    s_cselect_b32 s56, s47, -2
    s_cselect_b32 s47, s47, s41
    v_readlane_b32 s46, v234, s47
    s_cmp_ge_u32 s56, s59
    buffer_store_dword v65, v233, s[20:23], s55 offen offset:256
    v_cvt_pk_bf16_f32 v64, v16, v17
    v_cvt_pk_bf16_f32 v66, v24, v25
    buffer_store_dword v64, v233, s[20:23], s55 offen offset:0
    buffer_store_dword v66, v233, s[20:23], s55 offen offset:512
    s_cbranch_scc1 EP20_evt
EP20_go:
    s_cmp_eq_u32 s45, 0
    s_cbranch_scc1 S2f00
S2f01:
    v_mfma_f32_16x16x32_bf16 v[16:19], v[164:167], v[128:131], 0
    v_mul_f32_dpp v244, v222, v240 row_newbcast:1 row_mask:0xf bank_mask:0xf
    v_mul_f32_dpp v245, v222, v241 row_newbcast:5 row_mask:0xf bank_mask:0xf
    s_waitcnt vmcnt(7)
    ds_read_b64_tr_b16 v[144:145], v231 offset:2112
    ds_read_b64_tr_b16 v[148:149], v232 offset:2144
    ds_read_b64_tr_b16 v[152:153], v231 offset:2176
    ds_read_b64_tr_b16 v[156:157], v232 offset:2208
    v_mfma_f32_16x16x32_bf16 v[20:23], v[164:167], v[132:135], 0
    v_cvt_pk_bf16_f32 v174, v244, v245
    v_mul_f32_dpp v246, v222, v242 row_newbcast:9 row_mask:0xf bank_mask:0xf
    s_add_u32 m0, s51, 2112
    v_mfma_f32_16x16x32_bf16 v[8:11], v[164:167], v[136:139], 0
    v_mul_f32_dpp v247, v222, v243 row_newbcast:13 row_mask:0xf bank_mask:0xf
    v_cvt_pk_bf16_f32 v175, v246, v247
    s_waitcnt lgkmcnt(0)
    buffer_load_dwordx4 v226, s[4:7], s49 offen sc1 lds
    buffer_load_dwordx4 v227, s[4:7], s49 offen offset:1088 sc1 lds
    v_mfma_f32_16x16x32_bf16 v[12:15], v[164:167], v[140:143], 0
    v_mul_f32_dpp v244, v221, v236 row_newbcast:0 row_mask:0xf bank_mask:0xf
    v_mul_f32_dpp v245, v221, v237 row_newbcast:4 row_mask:0xf bank_mask:0xf
    v_mfma_f32_16x16x32_bf16 v[0:3], v[160:163], v[128:131], 0
    v_cvt_pk_bf16_f32 v168, v244, v245
    v_mfma_f32_16x16x32_bf16 v[4:7], v[160:163], v[132:135], 0
    v_mul_f32_dpp v246, v221, v238 row_newbcast:8 row_mask:0xf bank_mask:0xf
    v_mul_f32_dpp v247, v221, v239 row_newbcast:12 row_mask:0xf bank_mask:0xf
    v_mfma_f32_16x16x32_bf16 v[40:43], v[160:163], v[136:139], 0
    v_cvt_pk_bf16_f32 v169, v246, v247
    v_mul_f32_dpp v244, v221, v240 row_newbcast:1 row_mask:0xf bank_mask:0xf
    v_mfma_f32_16x16x32_bf16 v[44:47], v[160:163], v[140:143], 0
    v_mul_f32_dpp v245, v221, v241 row_newbcast:5 row_mask:0xf bank_mask:0xf
    v_cvt_pk_bf16_f32 v170, v244, v245
    v_mfma_f32_16x16x32_bf16 v[32:35], v[172:175], v[128:131], 0
    v_mul_f32_dpp v246, v221, v242 row_newbcast:9 row_mask:0xf bank_mask:0xf
    v_mul_f32_dpp v247, v221, v243 row_newbcast:13 row_mask:0xf bank_mask:0xf
    s_waitcnt vmcnt(7)
    ds_read_b64_tr_b16 v[146:147], v231 offset:4224
    ds_read_b64_tr_b16 v[150:151], v232 offset:4256
    ds_read_b64_tr_b16 v[154:155], v231 offset:4288
    ds_read_b64_tr_b16 v[158:159], v232 offset:4320
    v_mfma_f32_16x16x32_bf16 v[36:39], v[172:175], v[132:135], 0
    v_cvt_pk_bf16_f32 v171, v246, v247
    v_xor_b32 v176, s101, v164
    s_add_u32 m0, s51, 4224
    v_mfma_f32_16x16x32_bf16 v[72:75], v[172:175], v[136:139], 0
    v_xor_b32 v177, s101, v165
    v_add_u32_dpp v248, v235, v230 quad_perm:[2,2,2,2] row_mask:0xf bank_mask:0xf
    s_waitcnt lgkmcnt(0)
    buffer_load_dwordx4 v224, s[4:7], s50 offen sc1 lds
    buffer_load_dwordx4 v225, s[4:7], s50 offen offset:1088 sc1 lds
    v_mfma_f32_16x16x32_bf16 v[76:79], v[172:175], v[140:143], 0
    v_add_u32_dpp v249, v235, v230 quad_perm:[3,3,3,3] row_mask:0xf bank_mask:0xf
    ds_read_b64_tr_b16 v[252:253], v248
    ds_read_b64_tr_b16 v[254:255], v249
    v_xor_b32 v178, s101, v166
    v_mfma_f32_16x16x32_bf16 v[24:27], v[168:171], v[128:131], 0
    v_xor_b32 v179, s101, v167
    v_mfma_f32_16x16x32_bf16 v[28:31], v[168:171], v[132:135], 0
    v_xor_b32 v180, s101, v172
    v_xor_b32 v181, s101, v173
    v_mfma_f32_16x16x32_bf16 v[80:83], v[168:171], v[136:139], 0
    v_xor_b32 v182, s101, v174
    v_xor_b32 v183, s101, v175
    v_mfma_f32_16x16x32_bf16 v[84:87], v[168:171], v[140:143], 0
    s_waitcnt lgkmcnt(0)
    v_lshlrev_b32 v236, 16, v252
    v_and_b32 v237, s100, v252
    v_mfma_f32_16x16x32_bf16 v[84:87], v[176:179], v[148:151], v[84:87]
    v_lshlrev_b32 v238, 16, v253
    v_and_b32 v239, s100, v253
    s_waitcnt vmcnt(7)
    ds_read_b64_tr_b16 v[128:129], v231 offset:0
    ds_read_b64_tr_b16 v[132:133], v232 offset:32
    ds_read_b64_tr_b16 v[136:137], v231 offset:64
    ds_read_b64_tr_b16 v[140:141], v232 offset:96
    v_mfma_f32_16x16x32_bf16 v[80:83], v[176:179], v[144:147], v[80:83]
    v_lshlrev_b32 v240, 16, v254
    v_and_b32 v241, s100, v254
    s_add_u32 m0, s51, 0
    v_mfma_f32_16x16x32_bf16 v[72:75], v[176:179], v[152:155], v[72:75]
    v_lshlrev_b32 v242, 16, v255
    v_and_b32 v243, s100, v255
    s_waitcnt lgkmcnt(0)
    buffer_load_dwordx4 v226, s[4:7], s50 offen sc1 lds
    buffer_load_dwordx4 v227, s[4:7], s50 offen offset:1088 sc1 lds
    v_mfma_f32_16x16x32_bf16 v[76:79], v[176:179], v[156:159], v[76:79]
    v_mul_f32_dpp v244, v220, v236 row_newbcast:2 row_mask:0xf bank_mask:0xf
    v_mul_f32_dpp v245, v220, v237 row_newbcast:6 row_mask:0xf bank_mask:0xf
    v_mfma_f32_16x16x32_bf16 v[48:51], v[160:163], v[144:147], 0
    v_cvt_pk_bf16_f32 v164, v244, v245
    v_mfma_f32_16x16x32_bf16 v[52:55], v[160:163], v[148:151], 0
    s_add_u32 s45, s45, 1
    s_cmp_lt_u32 s45, s44
    s_cbranch_scc0 S2f01_w
S2f01_b:
    s_lshr_b32 s54, s45, 1
    s_set_gpr_idx_on s54, gpr_idx(SRC0)
    v_mov_b32 v223, v188
    s_set_gpr_idx_off
    v_mul_f32_dpp v246, v220, v238 row_newbcast:10 row_mask:0xf bank_mask:0xf
    v_mfma_f32_16x16x32_bf16 v[56:59], v[160:163], v[152:155], 0
    v_mov_b32_dpp v223, v223 row_shr:4 row_mask:0xf bank_mask:0xa
    v_mul_f32_dpp v247, v220, v239 row_newbcast:14 row_mask:0xf bank_mask:0xf
    v_mfma_f32_16x16x32_bf16 v[60:63], v[160:163], v[156:159], 0
    v_cvt_pk_bf16_f32 v165, v246, v247
    v_add_u32_dpp v224, v223, v228 quad_perm:[0,0,0,0] row_mask:0xf bank_mask:0xf
    v_mfma_f32_16x16x32_bf16 v[8:11], v[168:171], v[144:147], v[8:11]
    v_add_u32_dpp v225, v223, v229 quad_perm:[1,1,1,1] row_mask:0xf bank_mask:0xf
    v_mul_f32_dpp v244, v220, v240 row_newbcast:3 row_mask:0xf bank_mask:0xf
    s_waitcnt vmcnt(4)
    ds_read_b64_tr_b16 v[130:131], v231 offset:2112
    ds_read_b64_tr_b16 v[134:135], v232 offset:2144
    ds_read_b64_tr_b16 v[138:139], v231 offset:2176
    ds_read_b64_tr_b16 v[142:143], v232 offset:2208
    v_mfma_f32_16x16x32_bf16 v[8:11], v[172:175], v[152:155], v[8:11]
    v_mul_f32_dpp v245, v220, v241 row_newbcast:7 row_mask:0xf bank_mask:0xf
    v_cvt_pk_bf16_f32 v166, v244, v245
    s_add_u32 m0, s51, 2112
    v_mfma_f32_16x16x32_bf16 v[12:15], v[168:171], v[148:151], v[12:15]
    v_mul_f32_dpp v246, v220, v242 row_newbcast:11 row_mask:0xf bank_mask:0xf
    v_mul_f32_dpp v247, v220, v243 row_newbcast:15 row_mask:0xf bank_mask:0xf
    s_waitcnt lgkmcnt(0)
    buffer_load_dwordx4 v224, s[4:7], s49 offen sc1 lds
    buffer_load_dwordx4 v225, s[4:7], s49 offen offset:1088 sc1 lds
    v_mfma_f32_16x16x32_bf16 v[12:15], v[172:175], v[156:159], v[12:15]
    v_cvt_pk_bf16_f32 v167, v246, v247
    v_add_u32_dpp v226, v223, v228 quad_perm:[2,2,2,2] row_mask:0xf bank_mask:0xf
    v_mfma_f32_16x16x32_bf16 v[64:67], v[180:183], v[144:147], 0
    v_add_u32_dpp v227, v223, v229 quad_perm:[3,3,3,3] row_mask:0xf bank_mask:0xf
    v_mfma_f32_16x16x32_bf16 v[64:67], v[168:171], v[152:155], v[64:67]
    v_mul_f32_dpp v244, v222, v236 row_newbcast:2 row_mask:0xf bank_mask:0xf
    v_mul_f32_dpp v245, v222, v237 row_newbcast:6 row_mask:0xf bank_mask:0xf
    v_mfma_f32_16x16x32_bf16 v[68:71], v[180:183], v[148:151], 0
    v_cvt_pk_bf16_f32 v172, v244, v245
    v_mul_f32_dpp v246, v222, v238 row_newbcast:10 row_mask:0xf bank_mask:0xf
    v_mfma_f32_16x16x32_bf16 v[68:71], v[168:171], v[156:159], v[68:71]
    v_mul_f32_dpp v247, v222, v239 row_newbcast:14 row_mask:0xf bank_mask:0xf
    v_cvt_pk_bf16_f32 v173, v246, v247
    s_sub_u32 s46, s46, 1
    s_cbranch_scc1 EP01
S0n10:
    v_mfma_f32_16x16x32_bf16 v[16:19], v[164:167], v[128:131], v[16:19]
    v_mul_f32_dpp v244, v222, v240 row_newbcast:3 row_mask:0xf bank_mask:0xf
    v_mul_f32_dpp v245, v222, v241 row_newbcast:7 row_mask:0xf bank_mask:0xf
    s_waitcnt vmcnt(4)
    ds_read_b64_tr_b16 v[144:145], v231 offset:4224
    ds_read_b64_tr_b16 v[148:149], v232 offset:4256
    ds_read_b64_tr_b16 v[152:153], v231 offset:4288
    ds_read_b64_tr_b16 v[156:157], v232 offset:4320
    v_mfma_f32_16x16x32_bf16 v[20:23], v[164:167], v[132:135], v[20:23]
    v_cvt_pk_bf16_f32 v174, v244, v245
    v_mul_f32_dpp v246, v222, v242 row_newbcast:11 row_mask:0xf bank_mask:0xf
    s_add_u32 m0, s51, 4224
    v_mfma_f32_16x16x32_bf16 v[8:11], v[164:167], v[136:139], v[8:11]
    v_mul_f32_dpp v247, v222, v243 row_newbcast:15 row_mask:0xf bank_mask:0xf
    v_cvt_pk_bf16_f32 v175, v246, v247
    s_waitcnt lgkmcnt(0)
    buffer_load_dwordx4 v226, s[4:7], s49 offen sc1 lds
    buffer_load_dwordx4 v227, s[4:7], s49 offen offset:1088 sc1 lds
    v_mfma_f32_16x16x32_bf16 v[12:15], v[164:167], v[140:143], v[12:15]
    v_mul_f32_dpp v244, v221, v236 row_newbcast:2 row_mask:0xf bank_mask:0xf
    v_mul_f32_dpp v245, v221, v237 row_newbcast:6 row_mask:0xf bank_mask:0xf
    v_mfma_f32_16x16x32_bf16 v[0:3], v[252:255], v[128:131], v[0:3]
    v_cvt_pk_bf16_f32 v168, v244, v245
    v_mul_f32_dpp v246, v221, v238 row_newbcast:10 row_mask:0xf bank_mask:0xf
    v_mfma_f32_16x16x32_bf16 v[4:7], v[252:255], v[132:135], v[4:7]
    v_mul_f32_dpp v247, v221, v239 row_newbcast:14 row_mask:0xf bank_mask:0xf
    v_cvt_pk_bf16_f32 v169, v246, v247
    v_mfma_f32_16x16x32_bf16 v[40:43], v[252:255], v[136:139], v[40:43]
    v_mul_f32_dpp v244, v221, v240 row_newbcast:3 row_mask:0xf bank_mask:0xf
    v_mul_f32_dpp v245, v221, v241 row_newbcast:7 row_mask:0xf bank_mask:0xf
    v_mfma_f32_16x16x32_bf16 v[44:47], v[252:255], v[140:143], v[44:47]
    v_cvt_pk_bf16_f32 v170, v244, v245
    v_mul_f32_dpp v246, v221, v242 row_newbcast:11 row_mask:0xf bank_mask:0xf
    v_mfma_f32_16x16x32_bf16 v[32:35], v[172:175], v[128:131], v[32:35]
    v_mul_f32_dpp v247, v221, v243 row_newbcast:15 row_mask:0xf bank_mask:0xf
    v_cvt_pk_bf16_f32 v171, v246, v247
    s_waitcnt vmcnt(4)
    ds_read_b64_tr_b16 v[146:147], v231 offset:0
    ds_read_b64_tr_b16 v[150:151], v232 offset:32
    ds_read_b64_tr_b16 v[154:155], v231 offset:64
    ds_read_b64_tr_b16 v[158:159], v232 offset:96
    v_mfma_f32_16x16x32_bf16 v[36:39], v[172:175], v[132:135], v[36:39]
    s_set_gpr_idx_on s45, gpr_idx(SRC1)
    v_mad_u32_u16 v235, 8, v199, 0
    v_lshlrev_b32 v220, 16, v198
    v_and_b32 v221, s100, v198
    v_and_b32 v222, s100, v199
    s_set_gpr_idx_off
    s_add_u32 m0, s51, 0
    v_mfma_f32_16x16x32_bf16 v[72:75], v[172:175], v[136:139], v[72:75]
    s_waitcnt lgkmcnt(0)
    buffer_load_dwordx4 v224, s[4:7], s50 offen sc1 lds
    buffer_load_dwordx4 v225, s[4:7], s50 offen offset:1088 sc1 lds
    v_mfma_f32_16x16x32_bf16 v[76:79], v[172:175], v[140:143], v[76:79]
    v_xor_b32 v176, s101, v164
    v_xor_b32 v177, s101, v165
    v_mfma_f32_16x16x32_bf16 v[24:27], v[168:171], v[128:131], v[24:27]
    v_add_u32_dpp v248, v235, v230 quad_perm:[0,0,0,0] row_mask:0xf bank_mask:0xf
    v_add_u32_dpp v249, v235, v230 quad_perm:[1,1,1,1] row_mask:0xf bank_mask:0xf
    ds_read_b64_tr_b16 v[160:161], v248
    ds_read_b64_tr_b16 v[162:163], v249
    v_mfma_f32_16x16x32_bf16 v[28:31], v[168:171], v[132:135], v[28:31]
    v_xor_b32 v178, s101, v166
    v_xor_b32 v179, s101, v167
    v_mfma_f32_16x16x32_bf16 v[80:83], v[168:171], v[136:139], v[80:83]
    v_xor_b32 v180, s101, v172
    v_xor_b32 v181, s101, v173
    v_mfma_f32_16x16x32_bf16 v[84:87], v[168:171], v[140:143], v[84:87]
    v_xor_b32 v182, s101, v174
    v_xor_b32 v183, s101, v175
    v_mfma_f32_16x16x32_bf16 v[84:87], v[176:179], v[148:151], v[84:87]
    s_waitcnt lgkmcnt(0)
    v_lshlrev_b32 v236, 16, v160
    v_and_b32 v237, s100, v160
    s_waitcnt vmcnt(4)
    ds_read_b64_tr_b16 v[128:129], v231 offset:2112
    ds_read_b64_tr_b16 v[132:133], v232 offset:2144
    ds_read_b64_tr_b16 v[136:137], v231 offset:2176
    ds_read_b64_tr_b16 v[140:141], v232 offset:2208
    v_mfma_f32_16x16x32_bf16 v[80:83], v[176:179], v[144:147], v[80:83]
    v_lshlrev_b32 v238, 16, v161
    v_and_b32 v239, s100, v161
    s_add_u32 m0, s51, 2112
    v_mfma_f32_16x16x32_bf16 v[72:75], v[176:179], v[152:155], v[72:75]
    v_lshlrev_b32 v240, 16, v162
    v_and_b32 v241, s100, v162
    s_waitcnt lgkmcnt(0)
    buffer_load_dwordx4 v226, s[4:7], s50 offen sc1 lds
    buffer_load_dwordx4 v227, s[4:7], s50 offen offset:1088 sc1 lds
    v_mfma_f32_16x16x32_bf16 v[76:79], v[176:179], v[156:159], v[76:79]
    v_lshlrev_b32 v242, 16, v163
    v_and_b32 v243, s100, v163
    v_mfma_f32_16x16x32_bf16 v[48:51], v[252:255], v[144:147], v[48:51]
    v_mul_f32_dpp v244, v220, v236 row_newbcast:0 row_mask:0xf bank_mask:0xf
    v_mul_f32_dpp v245, v220, v237 row_newbcast:4 row_mask:0xf bank_mask:0xf
    v_mfma_f32_16x16x32_bf16 v[52:55], v[252:255], v[148:151], v[52:55]
    v_cvt_pk_bf16_f32 v164, v244, v245
    v_mfma_f32_16x16x32_bf16 v[56:59], v[252:255], v[152:155], v[56:59]
    s_add_u32 s45, s45, 1
    s_cmp_lt_u32 s45, s44
    s_cbranch_scc0 S0n10_w
    s_lshr_b32 s54, s45, 1
    s_set_gpr_idx_on s54, gpr_idx(SRC0)
    v_mov_b32 v223, v188
    s_set_gpr_idx_off
    v_mul_f32_dpp v246, v220, v238 row_newbcast:8 row_mask:0xf bank_mask:0xf
    v_mov_b32_dpp v223, v223 row_shl:4 row_mask:0xf bank_mask:0x5
S0n10_b:
    v_mfma_f32_16x16x32_bf16 v[60:63], v[252:255], v[156:159], v[60:63]
    v_mul_f32_dpp v247, v220, v239 row_newbcast:12 row_mask:0xf bank_mask:0xf
    v_cvt_pk_bf16_f32 v165, v246, v247
    v_mfma_f32_16x16x32_bf16 v[8:11], v[168:171], v[144:147], v[8:11]
    v_add_u32_dpp v224, v223, v228 quad_perm:[0,0,0,0] row_mask:0xf bank_mask:0xf
    v_add_u32_dpp v225, v223, v229 quad_perm:[1,1,1,1] row_mask:0xf bank_mask:0xf
    s_waitcnt vmcnt(4)
    ds_read_b64_tr_b16 v[130:131], v231 offset:4224
    ds_read_b64_tr_b16 v[134:135], v232 offset:4256
    ds_read_b64_tr_b16 v[138:139], v231 offset:4288
    ds_read_b64_tr_b16 v[142:143], v232 offset:4320
    v_mfma_f32_16x16x32_bf16 v[8:11], v[172:175], v[152:155], v[8:11]
    v_mul_f32_dpp v244, v220, v240 row_newbcast:1 row_mask:0xf bank_mask:0xf
    v_mul_f32_dpp v245, v220, v241 row_newbcast:5 row_mask:0xf bank_mask:0xf
    s_add_u32 m0, s51, 4224
    v_mfma_f32_16x16x32_bf16 v[12:15], v[168:171], v[148:151], v[12:15]
    v_cvt_pk_bf16_f32 v166, v244, v245
    v_mul_f32_dpp v246, v220, v242 row_newbcast:9 row_mask:0xf bank_mask:0xf
    s_waitcnt lgkmcnt(0)
    buffer_load_dwordx4 v224, s[4:7], s49 offen sc1 lds
    buffer_load_dwordx4 v225, s[4:7], s49 offen offset:1088 sc1 lds
    v_mfma_f32_16x16x32_bf16 v[12:15], v[172:175], v[156:159], v[12:15]
    v_mul_f32_dpp v247, v220, v243 row_newbcast:13 row_mask:0xf bank_mask:0xf
    v_cvt_pk_bf16_f32 v167, v246, v247
    v_mfma_f32_16x16x32_bf16 v[64:67], v[180:183], v[144:147], v[64:67]
    v_add_u32_dpp v226, v223, v228 quad_perm:[2,2,2,2] row_mask:0xf bank_mask:0xf
    v_add_u32_dpp v227, v223, v229 quad_perm:[3,3,3,3] row_mask:0xf bank_mask:0xf
    v_mfma_f32_16x16x32_bf16 v[64:67], v[168:171], v[152:155], v[64:67]
    v_mul_f32_dpp v244, v222, v236 row_newbcast:0 row_mask:0xf bank_mask:0xf
    v_mul_f32_dpp v245, v222, v237 row_newbcast:4 row_mask:0xf bank_mask:0xf
    v_mfma_f32_16x16x32_bf16 v[68:71], v[180:183], v[148:151], v[68:71]
    v_cvt_pk_bf16_f32 v172, v244, v245
    v_mul_f32_dpp v246, v222, v238 row_newbcast:8 row_mask:0xf bank_mask:0xf
    v_mfma_f32_16x16x32_bf16 v[68:71], v[168:171], v[156:159], v[68:71]
    v_mul_f32_dpp v247, v222, v239 row_newbcast:12 row_mask:0xf bank_mask:0xf
    v_cvt_pk_bf16_f32 v173, v246, v247
    s_sub_u32 s46, s46, 1
    s_cbranch_scc0 S0n10_c
EP10:
    s_setprio 0
    v_mul_f32 v16, v16, v104
    v_mul_f32 v20, v20, v108
    v_fmac_f32 v16, v17, v105
    v_fmac_f32 v20, v21, v109
    v_fmac_f32 v16, v18, v106
    v_fmac_f32 v20, v22, v110
    v_fmac_f32 v16, v19, v107
    v_fmac_f32 v20, v23, v111
    v_cvt_pk_bf16_f32 v146, v16, v20
    v_mul_f32 v0, v0, v88
    v_mul_f32 v4, v4, v92
    v_fmac_f32 v0, v1, v89
    v_fmac_f32 v4, v5, v93
    v_fmac_f32 v0, v2, v90
    v_fmac_f32 v4, v6, v94
    v_fmac_f32 v0, v3, v91
    v_fmac_f32 v4, v7, v95
    v_cvt_pk_bf16_f32 v144, v0, v4
    v_mov_b32 v155, 0
    v_mul_f32 v40, v40, v112
    v_mul_f32 v44, v44, v116
    v_fmac_f32 v40, v41, v113
    v_fmac_f32 v44, v45, v117
    v_fmac_f32 v40, v42, v114
    v_fmac_f32 v44, v46, v118
    v_fmac_f32 v40, v43, v115
    v_fmac_f32 v44, v47, v119
    v_cvt_pk_bf16_f32 v149, v40, v44
    v_mul_f32 v32, v32, v104
    v_mul_f32 v36, v36, v108
    v_fmac_f32 v32, v33, v105
    v_fmac_f32 v36, v37, v109
    v_fmac_f32 v32, v34, v106
    v_fmac_f32 v36, v38, v110
    v_fmac_f32 v32, v35, v107
    v_fmac_f32 v36, v39, v111
    v_cvt_pk_bf16_f32 v148, v32, v36
    v_mul_f32 v24, v24, v104
    v_mul_f32 v28, v28, v108
    v_fmac_f32 v24, v25, v105
    v_fmac_f32 v28, v29, v109
    v_fmac_f32 v24, v26, v106
    v_fmac_f32 v28, v30, v110
    v_fmac_f32 v24, v27, v107
    v_fmac_f32 v28, v31, v111
    v_cvt_pk_bf16_f32 v147, v24, v28
    v_mul_f32 v80, v80, v120
    v_mul_f32 v84, v84, v124
    v_fmac_f32 v80, v81, v121
    v_fmac_f32 v84, v85, v125
    v_fmac_f32 v80, v82, v122
    v_fmac_f32 v84, v86, v126
    v_fmac_f32 v80, v83, v123
    v_fmac_f32 v84, v87, v127
    v_cvt_pk_bf16_f32 v154, -v80, -v84
    v_mul_f32 v72, v72, v120
    v_mul_f32 v76, v76, v124
    v_fmac_f32 v72, v73, v121
    v_fmac_f32 v76, v77, v125
    v_fmac_f32 v72, v74, v122
    v_fmac_f32 v76, v78, v126
    v_fmac_f32 v72, v75, v123
    v_fmac_f32 v76, v79, v127
    v_cvt_pk_bf16_f32 v153, v72, v76
    v_mul_f32 v48, v48, v112
    v_mul_f32 v52, v52, v116
    v_fmac_f32 v48, v49, v113
    v_fmac_f32 v52, v53, v117
    v_fmac_f32 v48, v50, v114
    v_fmac_f32 v52, v54, v118
    v_fmac_f32 v48, v51, v115
    v_fmac_f32 v52, v55, v119
    v_cvt_pk_bf16_f32 v150, v48, v52
    v_mul_f32 v56, v56, v112
    v_mul_f32 v60, v60, v116
    v_fmac_f32 v56, v57, v113
    v_fmac_f32 v60, v61, v117
    v_fmac_f32 v56, v58, v114
    v_fmac_f32 v60, v62, v118
    v_fmac_f32 v56, v59, v115
    v_fmac_f32 v60, v63, v119
    v_cvt_pk_bf16_f32 v151, v56, v60
    v_mul_f32 v8, v8, v96
    v_mul_f32 v12, v12, v100
    v_fmac_f32 v8, v9, v97
    v_fmac_f32 v12, v13, v101
    v_fmac_f32 v8, v10, v98
    v_fmac_f32 v12, v14, v102
    v_fmac_f32 v8, v11, v99
    v_fmac_f32 v12, v15, v103
    v_cvt_pk_bf16_f32 v145, v8, v12
    v_mfma_f32_16x16x32_bf16 v[20:23], v[184:187], v[148:151], 0
    v_mul_f32 v64, v64, v120
    v_mul_f32 v68, v68, v124
    v_fmac_f32 v64, v65, v121
    v_fmac_f32 v68, v69, v125
    v_fmac_f32 v64, v66, v122
    v_fmac_f32 v68, v70, v126
    v_fmac_f32 v64, v67, v123
    v_fmac_f32 v68, v71, v127
    v_cvt_pk_bf16_f32 v152, v64, v68
    s_ashr_i32 s58, s58, 1
    s_bitcmp1_b32 s58, 0
    s_cbranch_scc0 EP10_p
    s_setprio 1
EP10_p:
    s_mul_i32 s55, s47, 784
    v_mfma_f32_16x16x32_bf16 v[16:19], v[184:187], v[144:147], 0
    v_mfma_f32_16x16x32_bf16 v[24:27], v[184:187], v[152:155], 0
    v_cvt_pk_bf16_f32 v65, v20, v21
    s_add_u32 s55, s55, s52
    s_add_u32 s47, s47, 1
    s_cmp_lt_u32 s47, s79
    s_cselect_b32 s56, s47, -2
    s_cselect_b32 s47, s47, s41
    v_readlane_b32 s46, v234, s47
    s_cmp_ge_u32 s56, s59
    buffer_store_dword v65, v233, s[20:23], s55 offen offset:256
    v_cvt_pk_bf16_f32 v64, v16, v17
    v_cvt_pk_bf16_f32 v66, v24, v25
    buffer_store_dword v64, v233, s[20:23], s55 offen offset:0
    buffer_store_dword v66, v233, s[20:23], s55 offen offset:512
    s_cbranch_scc1 EP10_evt
EP10_go:
    s_cmp_eq_u32 s45, 0
    s_cbranch_scc1 S1f00
S1f01:
    v_mfma_f32_16x16x32_bf16 v[16:19], v[164:167], v[128:131], 0
    v_mul_f32_dpp v244, v222, v240 row_newbcast:1 row_mask:0xf bank_mask:0xf
    v_mul_f32_dpp v245, v222, v241 row_newbcast:5 row_mask:0xf bank_mask:0xf
    s_waitcnt vmcnt(7)
    ds_read_b64_tr_b16 v[144:145], v231 offset:0
    ds_read_b64_tr_b16 v[148:149], v232 offset:32
    ds_read_b64_tr_b16 v[152:153], v231 offset:64
    ds_read_b64_tr_b16 v[156:157], v232 offset:96
    v_mfma_f32_16x16x32_bf16 v[20:23], v[164:167], v[132:135], 0
    v_cvt_pk_bf16_f32 v174, v244, v245
    v_mul_f32_dpp v246, v222, v242 row_newbcast:9 row_mask:0xf bank_mask:0xf
    s_add_u32 m0, s51, 0
    v_mfma_f32_16x16x32_bf16 v[8:11], v[164:167], v[136:139], 0
    v_mul_f32_dpp v247, v222, v243 row_newbcast:13 row_mask:0xf bank_mask:0xf
    v_cvt_pk_bf16_f32 v175, v246, v247
    s_waitcnt lgkmcnt(0)
    buffer_load_dwordx4 v226, s[4:7], s49 offen sc1 lds
    buffer_load_dwordx4 v227, s[4:7], s49 offen offset:1088 sc1 lds
    v_mfma_f32_16x16x32_bf16 v[12:15], v[164:167], v[140:143], 0
    v_mul_f32_dpp v244, v221, v236 row_newbcast:0 row_mask:0xf bank_mask:0xf
    v_mul_f32_dpp v245, v221, v237 row_newbcast:4 row_mask:0xf bank_mask:0xf
    v_mfma_f32_16x16x32_bf16 v[0:3], v[160:163], v[128:131], 0
    v_cvt_pk_bf16_f32 v168, v244, v245
    v_mfma_f32_16x16x32_bf16 v[4:7], v[160:163], v[132:135], 0
    v_mul_f32_dpp v246, v221, v238 row_newbcast:8 row_mask:0xf bank_mask:0xf
    v_mul_f32_dpp v247, v221, v239 row_newbcast:12 row_mask:0xf bank_mask:0xf
    v_mfma_f32_16x16x32_bf16 v[40:43], v[160:163], v[136:139], 0
    v_cvt_pk_bf16_f32 v169, v246, v247
    v_mul_f32_dpp v244, v221, v240 row_newbcast:1 row_mask:0xf bank_mask:0xf
    v_mfma_f32_16x16x32_bf16 v[44:47], v[160:163], v[140:143], 0
    v_mul_f32_dpp v245, v221, v241 row_newbcast:5 row_mask:0xf bank_mask:0xf
    v_cvt_pk_bf16_f32 v170, v244, v245
    v_mfma_f32_16x16x32_bf16 v[32:35], v[172:175], v[128:131], 0
    v_mul_f32_dpp v246, v221, v242 row_newbcast:9 row_mask:0xf bank_mask:0xf
    v_mul_f32_dpp v247, v221, v243 row_newbcast:13 row_mask:0xf bank_mask:0xf
    s_waitcnt vmcnt(7)
    ds_read_b64_tr_b16 v[146:147], v231 offset:2112
    ds_read_b64_tr_b16 v[150:151], v232 offset:2144
    ds_read_b64_tr_b16 v[154:155], v231 offset:2176
    ds_read_b64_tr_b16 v[158:159], v232 offset:2208
    v_mfma_f32_16x16x32_bf16 v[36:39], v[172:175], v[132:135], 0
    v_cvt_pk_bf16_f32 v171, v246, v247
    v_xor_b32 v176, s101, v164
    s_add_u32 m0, s51, 2112
    v_mfma_f32_16x16x32_bf16 v[72:75], v[172:175], v[136:139], 0
    v_xor_b32 v177, s101, v165
    v_add_u32_dpp v248, v235, v230 quad_perm:[2,2,2,2] row_mask:0xf bank_mask:0xf
    s_waitcnt lgkmcnt(0)
    buffer_load_dwordx4 v224, s[4:7], s50 offen sc1 lds
    buffer_load_dwordx4 v225, s[4:7], s50 offen offset:1088 sc1 lds
    v_mfma_f32_16x16x32_bf16 v[76:79], v[172:175], v[140:143], 0
    v_add_u32_dpp v249, v235, v230 quad_perm:[3,3,3,3] row_mask:0xf bank_mask:0xf
    ds_read_b64_tr_b16 v[252:253], v248
    ds_read_b64_tr_b16 v[254:255], v249
    v_xor_b32 v178, s101, v166
    v_mfma_f32_16x16x32_bf16 v[24:27], v[168:171], v[128:131], 0
    v_xor_b32 v179, s101, v167
    v_mfma_f32_16x16x32_bf16 v[28:31], v[168:171], v[132:135], 0
    v_xor_b32 v180, s101, v172
    v_xor_b32 v181, s101, v173
    v_mfma_f32_16x16x32_bf16 v[80:83], v[168:171], v[136:139], 0
    v_xor_b32 v182, s101, v174
    v_xor_b32 v183, s101, v175
    v_mfma_f32_16x16x32_bf16 v[84:87], v[168:171], v[140:143], 0
    s_waitcnt lgkmcnt(0)
    v_lshlrev_b32 v236, 16, v252
    v_and_b32 v237, s100, v252
    v_mfma_f32_16x16x32_bf16 v[84:87], v[176:179], v[148:151], v[84:87]
    v_lshlrev_b32 v238, 16, v253
    v_and_b32 v239, s100, v253
    s_waitcnt vmcnt(7)
    ds_read_b64_tr_b16 v[128:129], v231 offset:4224
    ds_read_b64_tr_b16 v[132:133], v232 offset:4256
    ds_read_b64_tr_b16 v[136:137], v231 offset:4288
    ds_read_b64_tr_b16 v[140:141], v232 offset:4320
    v_mfma_f32_16x16x32_bf16 v[80:83], v[176:179], v[144:147], v[80:83]
    v_lshlrev_b32 v240, 16, v254
    v_and_b32 v241, s100, v254
    s_add_u32 m0, s51, 4224
    v_mfma_f32_16x16x32_bf16 v[72:75], v[176:179], v[152:155], v[72:75]
    v_lshlrev_b32 v242, 16, v255
    v_and_b32 v243, s100, v255
    s_waitcnt lgkmcnt(0)
    buffer_load_dwordx4 v226, s[4:7], s50 offen sc1 lds
    buffer_load_dwordx4 v227, s[4:7], s50 offen offset:1088 sc1 lds
    v_mfma_f32_16x16x32_bf16 v[76:79], v[176:179], v[156:159], v[76:79]
    v_mul_f32_dpp v244, v220, v236 row_newbcast:2 row_mask:0xf bank_mask:0xf
    v_mul_f32_dpp v245, v220, v237 row_newbcast:6 row_mask:0xf bank_mask:0xf
    v_mfma_f32_16x16x32_bf16 v[48:51], v[160:163], v[144:147], 0
    v_cvt_pk_bf16_f32 v164, v244, v245
    v_mfma_f32_16x16x32_bf16 v[52:55], v[160:163], v[148:151], 0
    s_add_u32 s45, s45, 1
    s_cmp_lt_u32 s45, s44
    s_cbranch_scc0 S1f01_w
S1f01_b:
    s_lshr_b32 s54, s45, 1
    s_set_gpr_idx_on s54, gpr_idx(SRC0)
    v_mov_b32 v223, v188
    s_set_gpr_idx_off
    v_mul_f32_dpp v246, v220, v238 row_newbcast:10 row_mask:0xf bank_mask:0xf
    v_mfma_f32_16x16x32_bf16 v[56:59], v[160:163], v[152:155], 0
    v_mov_b32_dpp v223, v223 row_shr:4 row_mask:0xf bank_mask:0xa
    v_mul_f32_dpp v247, v220, v239 row_newbcast:14 row_mask:0xf bank_mask:0xf
    v_mfma_f32_16x16x32_bf16 v[60:63], v[160:163], v[156:159], 0
    v_cvt_pk_bf16_f32 v165, v246, v247
    v_add_u32_dpp v224, v223, v228 quad_perm:[0,0,0,0] row_mask:0xf bank_mask:0xf
    v_mfma_f32_16x16x32_bf16 v[8:11], v[168:171], v[144:147], v[8:11]
    v_add_u32_dpp v225, v223, v229 quad_perm:[1,1,1,1] row_mask:0xf bank_mask:0xf
    v_mul_f32_dpp v244, v220, v240 row_newbcast:3 row_mask:0xf bank_mask:0xf
    s_waitcnt vmcnt(4)
    ds_read_b64_tr_b16 v[130:131], v231 offset:0
    ds_read_b64_tr_b16 v[134:135], v232 offset:32
    ds_read_b64_tr_b16 v[138:139], v231 offset:64
    ds_read_b64_tr_b16 v[142:143], v232 offset:96
    v_mfma_f32_16x16x32_bf16 v[8:11], v[172:175], v[152:155], v[8:11]
    v_mul_f32_dpp v245, v220, v241 row_newbcast:7 row_mask:0xf bank_mask:0xf
    v_cvt_pk_bf16_f32 v166, v244, v245
    s_add_u32 m0, s51, 0
    v_mfma_f32_16x16x32_bf16 v[12:15], v[168:171], v[148:151], v[12:15]
    v_mul_f32_dpp v246, v220, v242 row_newbcast:11 row_mask:0xf bank_mask:0xf
    v_mul_f32_dpp v247, v220, v243 row_newbcast:15 row_mask:0xf bank_mask:0xf
    s_waitcnt lgkmcnt(0)
    buffer_load_dwordx4 v224, s[4:7], s49 offen sc1 lds
    buffer_load_dwordx4 v225, s[4:7], s49 offen offset:1088 sc1 lds
    v_mfma_f32_16x16x32_bf16 v[12:15], v[172:175], v[156:159], v[12:15]
    v_cvt_pk_bf16_f32 v167, v246, v247
    v_add_u32_dpp v226, v223, v228 quad_perm:[2,2,2,2] row_mask:0xf bank_mask:0xf
    v_mfma_f32_16x16x32_bf16 v[64:67], v[180:183], v[144:147], 0
    v_add_u32_dpp v227, v223, v229 quad_perm:[3,3,3,3] row_mask:0xf bank_mask:0xf
    v_mfma_f32_16x16x32_bf16 v[64:67], v[168:171], v[152:155], v[64:67]
    v_mul_f32_dpp v244, v222, v236 row_newbcast:2 row_mask:0xf bank_mask:0xf
    v_mul_f32_dpp v245, v222, v237 row_newbcast:6 row_mask:0xf bank_mask:0xf
    v_mfma_f32_16x16x32_bf16 v[68:71], v[180:183], v[148:151], 0
    v_cvt_pk_bf16_f32 v172, v244, v245
    v_mul_f32_dpp v246, v222, v238 row_newbcast:10 row_mask:0xf bank_mask:0xf
    v_mfma_f32_16x16x32_bf16 v[68:71], v[168:171], v[156:159], v[68:71]
    v_mul_f32_dpp v247, v222, v239 row_newbcast:14 row_mask:0xf bank_mask:0xf
    v_cvt_pk_bf16_f32 v173, v246, v247
    s_sub_u32 s46, s46, 1
    s_cbranch_scc1 EP21
S2n10:
    v_mfma_f32_16x16x32_bf16 v[16:19], v[164:167], v[128:131], v[16:19]
    v_mul_f32_dpp v244, v222, v240 row_newbcast:3 row_mask:0xf bank_mask:0xf
    v_mul_f32_dpp v245, v222, v241 row_newbcast:7 row_mask:0xf bank_mask:0xf
    s_waitcnt vmcnt(4)
    ds_read_b64_tr_b16 v[144:145], v231 offset:2112
    ds_read_b64_tr_b16 v[148:149], v232 offset:2144
    ds_read_b64_tr_b16 v[152:153], v231 offset:2176
    ds_read_b64_tr_b16 v[156:157], v232 offset:2208
    v_mfma_f32_16x16x32_bf16 v[20:23], v[164:167], v[132:135], v[20:23]
    v_cvt_pk_bf16_f32 v174, v244, v245
    v_mul_f32_dpp v246, v222, v242 row_newbcast:11 row_mask:0xf bank_mask:0xf
    s_add_u32 m0, s51, 2112
    v_mfma_f32_16x16x32_bf16 v[8:11], v[164:167], v[136:139], v[8:11]
    v_mul_f32_dpp v247, v222, v243 row_newbcast:15 row_mask:0xf bank_mask:0xf
    v_cvt_pk_bf16_f32 v175, v246, v247
    s_waitcnt lgkmcnt(0)
    buffer_load_dwordx4 v226, s[4:7], s49 offen sc1 lds
    buffer_load_dwordx4 v227, s[4:7], s49 offen offset:1088 sc1 lds
    v_mfma_f32_16x16x32_bf16 v[12:15], v[164:167], v[140:143], v[12:15]
    v_mul_f32_dpp v244, v221, v236 row_newbcast:2 row_mask:0xf bank_mask:0xf
    v_mul_f32_dpp v245, v221, v237 row_newbcast:6 row_mask:0xf bank_mask:0xf
    v_mfma_f32_16x16x32_bf16 v[0:3], v[252:255], v[128:131], v[0:3]
    v_cvt_pk_bf16_f32 v168, v244, v245
    v_mul_f32_dpp v246, v221, v238 row_newbcast:10 row_mask:0xf bank_mask:0xf
    v_mfma_f32_16x16x32_bf16 v[4:7], v[252:255], v[132:135], v[4:7]
    v_mul_f32_dpp v247, v221, v239 row_newbcast:14 row_mask:0xf bank_mask:0xf
    v_cvt_pk_bf16_f32 v169, v246, v247
    v_mfma_f32_16x16x32_bf16 v[40:43], v[252:255], v[136:139], v[40:43]
    v_mul_f32_dpp v244, v221, v240 row_newbcast:3 row_mask:0xf bank_mask:0xf
    v_mul_f32_dpp v245, v221, v241 row_newbcast:7 row_mask:0xf bank_mask:0xf
    v_mfma_f32_16x16x32_bf16 v[44:47], v[252:255], v[140:143], v[44:47]
    v_cvt_pk_bf16_f32 v170, v244, v245
    v_mul_f32_dpp v246, v221, v242 row_newbcast:11 row_mask:0xf bank_mask:0xf
    v_mfma_f32_16x16x32_bf16 v[32:35], v[172:175], v[128:131], v[32:35]
    v_mul_f32_dpp v247, v221, v243 row_newbcast:15 row_mask:0xf bank_mask:0xf
    v_cvt_pk_bf16_f32 v171, v246, v247
    s_waitcnt vmcnt(4)
    ds_read_b64_tr_b16 v[146:147], v231 offset:4224
    ds_read_b64_tr_b16 v[150:151], v232 offset:4256
    ds_read_b64_tr_b16 v[154:155], v231 offset:4288
    ds_read_b64_tr_b16 v[158:159], v232 offset:4320
    v_mfma_f32_16x16x32_bf16 v[36:39], v[172:175], v[132:135], v[36:39]
    s_set_gpr_idx_on s45, gpr_idx(SRC1)
    v_mad_u32_u16 v235, 8, v199, 0
    v_lshlrev_b32 v220, 16, v198
    v_and_b32 v221, s100, v198
    v_and_b32 v222, s100, v199
    s_set_gpr_idx_off
    s_add_u32 m0, s51, 4224
    v_mfma_f32_16x16x32_bf16 v[72:75], v[172:175], v[136:139], v[72:75]
    s_waitcnt lgkmcnt(0)
    buffer_load_dwordx4 v224, s[4:7], s50 offen sc1 lds
    buffer_load_dwordx4 v225, s[4:7], s50 offen offset:1088 sc1 lds
    v_mfma_f32_16x16x32_bf16 v[76:79], v[172:175], v[140:143], v[76:79]
    v_xor_b32 v176, s101, v164
    v_xor_b32 v177, s101, v165
    v_mfma_f32_16x16x32_bf16 v[24:27], v[168:171], v[128:131], v[24:27]
    v_add_u32_dpp v248, v235, v230 quad_perm:[0,0,0,0] row_mask:0xf bank_mask:0xf
    v_add_u32_dpp v249, v235, v230 quad_perm:[1,1,1,1] row_mask:0xf bank_mask:0xf
    ds_read_b64_tr_b16 v[160:161], v248
    ds_read_b64_tr_b16 v[162:163], v249
    v_mfma_f32_16x16x32_bf16 v[28:31], v[168:171], v[132:135], v[28:31]
    v_xor_b32 v178, s101, v166
    v_xor_b32 v179, s101, v167
    v_mfma_f32_16x16x32_bf16 v[80:83], v[168:171], v[136:139], v[80:83]
    v_xor_b32 v180, s101, v172
    v_xor_b32 v181, s101, v173
    v_mfma_f32_16x16x32_bf16 v[84:87], v[168:171], v[140:143], v[84:87]
    v_xor_b32 v182, s101, v174
    v_xor_b32 v183, s101, v175
    v_mfma_f32_16x16x32_bf16 v[84:87], v[176:179], v[148:151], v[84:87]
    s_waitcnt lgkmcnt(0)
    v_lshlrev_b32 v236, 16, v160
    v_and_b32 v237, s100, v160
    s_waitcnt vmcnt(4)
    ds_read_b64_tr_b16 v[128:129], v231 offset:0
    ds_read_b64_tr_b16 v[132:133], v232 offset:32
    ds_read_b64_tr_b16 v[136:137], v231 offset:64
    ds_read_b64_tr_b16 v[140:141], v232 offset:96
    v_mfma_f32_16x16x32_bf16 v[80:83], v[176:179], v[144:147], v[80:83]
    v_lshlrev_b32 v238, 16, v161
    v_and_b32 v239, s100, v161
    s_add_u32 m0, s51, 0
    v_mfma_f32_16x16x32_bf16 v[72:75], v[176:179], v[152:155], v[72:75]
    v_lshlrev_b32 v240, 16, v162
    v_and_b32 v241, s100, v162
    s_waitcnt lgkmcnt(0)
    buffer_load_dwordx4 v226, s[4:7], s50 offen sc1 lds
    buffer_load_dwordx4 v227, s[4:7], s50 offen offset:1088 sc1 lds
    v_mfma_f32_16x16x32_bf16 v[76:79], v[176:179], v[156:159], v[76:79]
    v_lshlrev_b32 v242, 16, v163
    v_and_b32 v243, s100, v163
    v_mfma_f32_16x16x32_bf16 v[48:51], v[252:255], v[144:147], v[48:51]
    v_mul_f32_dpp v244, v220, v236 row_newbcast:0 row_mask:0xf bank_mask:0xf
    v_mul_f32_dpp v245, v220, v237 row_newbcast:4 row_mask:0xf bank_mask:0xf
    v_mfma_f32_16x16x32_bf16 v[52:55], v[252:255], v[148:151], v[52:55]
    v_cvt_pk_bf16_f32 v164, v244, v245
    v_mfma_f32_16x16x32_bf16 v[56:59], v[252:255], v[152:155], v[56:59]
    s_add_u32 s45, s45, 1
    s_cmp_lt_u32 s45, s44
    s_cbranch_scc0 S2n10_w
    s_lshr_b32 s54, s45, 1
    s_set_gpr_idx_on s54, gpr_idx(SRC0)
    v_mov_b32 v223, v188
    s_set_gpr_idx_off
    v_mul_f32_dpp v246, v220, v238 row_newbcast:8 row_mask:0xf bank_mask:0xf
    v_mov_b32_dpp v223, v223 row_shl:4 row_mask:0xf bank_mask:0x5
S2n10_b:
    v_mfma_f32_16x16x32_bf16 v[60:63], v[252:255], v[156:159], v[60:63]
    v_mul_f32_dpp v247, v220, v239 row_newbcast:12 row_mask:0xf bank_mask:0xf
    v_cvt_pk_bf16_f32 v165, v246, v247
    v_mfma_f32_16x16x32_bf16 v[8:11], v[168:171], v[144:147], v[8:11]
    v_add_u32_dpp v224, v223, v228 quad_perm:[0,0,0,0] row_mask:0xf bank_mask:0xf
    v_add_u32_dpp v225, v223, v229 quad_perm:[1,1,1,1] row_mask:0xf bank_mask:0xf
    s_waitcnt vmcnt(4)
    ds_read_b64_tr_b16 v[130:131], v231 offset:2112
    ds_read_b64_tr_b16 v[134:135], v232 offset:2144
    ds_read_b64_tr_b16 v[138:139], v231 offset:2176
    ds_read_b64_tr_b16 v[142:143], v232 offset:2208
    v_mfma_f32_16x16x32_bf16 v[8:11], v[172:175], v[152:155], v[8:11]
    v_mul_f32_dpp v244, v220, v240 row_newbcast:1 row_mask:0xf bank_mask:0xf
    v_mul_f32_dpp v245, v220, v241 row_newbcast:5 row_mask:0xf bank_mask:0xf
    s_add_u32 m0, s51, 2112
    v_mfma_f32_16x16x32_bf16 v[12:15], v[168:171], v[148:151], v[12:15]
    v_cvt_pk_bf16_f32 v166, v244, v245
    v_mul_f32_dpp v246, v220, v242 row_newbcast:9 row_mask:0xf bank_mask:0xf
    s_waitcnt lgkmcnt(0)
    buffer_load_dwordx4 v224, s[4:7], s49 offen sc1 lds
    buffer_load_dwordx4 v225, s[4:7], s49 offen offset:1088 sc1 lds
    v_mfma_f32_16x16x32_bf16 v[12:15], v[172:175], v[156:159], v[12:15]
    v_mul_f32_dpp v247, v220, v243 row_newbcast:13 row_mask:0xf bank_mask:0xf
    v_cvt_pk_bf16_f32 v167, v246, v247
    v_mfma_f32_16x16x32_bf16 v[64:67], v[180:183], v[144:147], v[64:67]
    v_add_u32_dpp v226, v223, v228 quad_perm:[2,2,2,2] row_mask:0xf bank_mask:0xf
    v_add_u32_dpp v227, v223, v229 quad_perm:[3,3,3,3] row_mask:0xf bank_mask:0xf
    v_mfma_f32_16x16x32_bf16 v[64:67], v[168:171], v[152:155], v[64:67]
    v_mul_f32_dpp v244, v222, v236 row_newbcast:0 row_mask:0xf bank_mask:0xf
    v_mul_f32_dpp v245, v222, v237 row_newbcast:4 row_mask:0xf bank_mask:0xf
    v_mfma_f32_16x16x32_bf16 v[68:71], v[180:183], v[148:151], v[68:71]
    v_cvt_pk_bf16_f32 v172, v244, v245
    v_mul_f32_dpp v246, v222, v238 row_newbcast:8 row_mask:0xf bank_mask:0xf
    v_mfma_f32_16x16x32_bf16 v[68:71], v[168:171], v[156:159], v[68:71]
    v_mul_f32_dpp v247, v222, v239 row_newbcast:12 row_mask:0xf bank_mask:0xf
    v_cvt_pk_bf16_f32 v173, v246, v247
    s_sub_u32 s46, s46, 1
    s_cbranch_scc0 S2n10_c
    s_branch EP00
EP01:
    s_setprio 0
    v_mul_f32 v16, v16, v104
    v_mul_f32 v20, v20, v108
    v_fmac_f32 v16, v17, v105
    v_fmac_f32 v20, v21, v109
    v_fmac_f32 v16, v18, v106
    v_fmac_f32 v20, v22, v110
    v_fmac_f32 v16, v19, v107
    v_fmac_f32 v20, v23, v111
    v_cvt_pk_bf16_f32 v146, v16, v20
    v_mul_f32 v0, v0, v88
    v_mul_f32 v4, v4, v92
    v_fmac_f32 v0, v1, v89
    v_fmac_f32 v4, v5, v93
    v_fmac_f32 v0, v2, v90
    v_fmac_f32 v4, v6, v94
    v_fmac_f32 v0, v3, v91
    v_fmac_f32 v4, v7, v95
    v_cvt_pk_bf16_f32 v144, v0, v4
    v_mov_b32 v155, 0
    v_mul_f32 v40, v40, v112
    v_mul_f32 v44, v44, v116
    v_fmac_f32 v40, v41, v113
    v_fmac_f32 v44, v45, v117
    v_fmac_f32 v40, v42, v114
    v_fmac_f32 v44, v46, v118
    v_fmac_f32 v40, v43, v115
    v_fmac_f32 v44, v47, v119
    v_cvt_pk_bf16_f32 v149, v40, v44
    v_mul_f32 v32, v32, v104
    v_mul_f32 v36, v36, v108
    v_fmac_f32 v32, v33, v105
    v_fmac_f32 v36, v37, v109
    v_fmac_f32 v32, v34, v106
    v_fmac_f32 v36, v38, v110
    v_fmac_f32 v32, v35, v107
    v_fmac_f32 v36, v39, v111
    v_cvt_pk_bf16_f32 v148, v32, v36
    v_mul_f32 v24, v24, v104
    v_mul_f32 v28, v28, v108
    v_fmac_f32 v24, v25, v105
    v_fmac_f32 v28, v29, v109
    v_fmac_f32 v24, v26, v106
    v_fmac_f32 v28, v30, v110
    v_fmac_f32 v24, v27, v107
    v_fmac_f32 v28, v31, v111
    v_cvt_pk_bf16_f32 v147, v24, v28
    v_mul_f32 v80, v80, v120
    v_mul_f32 v84, v84, v124
    v_fmac_f32 v80, v81, v121
    v_fmac_f32 v84, v85, v125
    v_fmac_f32 v80, v82, v122
    v_fmac_f32 v84, v86, v126
    v_fmac_f32 v80, v83, v123
    v_fmac_f32 v84, v87, v127
    v_cvt_pk_bf16_f32 v154, -v80, -v84
    v_mul_f32 v72, v72, v120
    v_mul_f32 v76, v76, v124
    v_fmac_f32 v72, v73, v121
    v_fmac_f32 v76, v77, v125
    v_fmac_f32 v72, v74, v122
    v_fmac_f32 v76, v78, v126
    v_fmac_f32 v72, v75, v123
    v_fmac_f32 v76, v79, v127
    v_cvt_pk_bf16_f32 v153, v72, v76
    v_mul_f32 v48, v48, v112
    v_mul_f32 v52, v52, v116
    v_fmac_f32 v48, v49, v113
    v_fmac_f32 v52, v53, v117
    v_fmac_f32 v48, v50, v114
    v_fmac_f32 v52, v54, v118
    v_fmac_f32 v48, v51, v115
    v_fmac_f32 v52, v55, v119
    v_cvt_pk_bf16_f32 v150, v48, v52
    v_mul_f32 v56, v56, v112
    v_mul_f32 v60, v60, v116
    v_fmac_f32 v56, v57, v113
    v_fmac_f32 v60, v61, v117
    v_fmac_f32 v56, v58, v114
    v_fmac_f32 v60, v62, v118
    v_fmac_f32 v56, v59, v115
    v_fmac_f32 v60, v63, v119
    v_cvt_pk_bf16_f32 v151, v56, v60
    v_mul_f32 v8, v8, v96
    v_mul_f32 v12, v12, v100
    v_fmac_f32 v8, v9, v97
    v_fmac_f32 v12, v13, v101
    v_fmac_f32 v8, v10, v98
    v_fmac_f32 v12, v14, v102
    v_fmac_f32 v8, v11, v99
    v_fmac_f32 v12, v15, v103
    v_cvt_pk_bf16_f32 v145, v8, v12
    v_mfma_f32_16x16x32_bf16 v[20:23], v[184:187], v[148:151], 0
    v_mul_f32 v64, v64, v120
    v_mul_f32 v68, v68, v124
    v_fmac_f32 v64, v65, v121
    v_fmac_f32 v68, v69, v125
    v_fmac_f32 v64, v66, v122
    v_fmac_f32 v68, v70, v126
    v_fmac_f32 v64, v67, v123
    v_fmac_f32 v68, v71, v127
    v_cvt_pk_bf16_f32 v152, v64, v68
    s_ashr_i32 s58, s58, 1
    s_bitcmp1_b32 s58, 0
    s_cbranch_scc0 EP01_p
    s_setprio 1
EP01_p:
    s_mul_i32 s55, s47, 784
    v_mfma_f32_16x16x32_bf16 v[16:19], v[184:187], v[144:147], 0
    v_mfma_f32_16x16x32_bf16 v[24:27], v[184:187], v[152:155], 0
    v_cvt_pk_bf16_f32 v65, v20, v21
    s_add_u32 s55, s55, s52
    s_add_u32 s47, s47, 1
    s_cmp_lt_u32 s47, s79
    s_cselect_b32 s56, s47, -2
    s_cselect_b32 s47, s47, s41
    v_readlane_b32 s46, v234, s47
    s_cmp_ge_u32 s56, s59
    buffer_store_dword v65, v233, s[20:23], s55 offen offset:256
    v_cvt_pk_bf16_f32 v64, v16, v17
    v_cvt_pk_bf16_f32 v66, v24, v25
    buffer_store_dword v64, v233, s[20:23], s55 offen offset:0
    buffer_store_dword v66, v233, s[20:23], s55 offen offset:512
    s_cbranch_scc1 EP01_evt
EP01_go:
S0f10:
    v_mfma_f32_16x16x32_bf16 v[16:19], v[164:167], v[128:131], 0
    v_mul_f32_dpp v244, v222, v240 row_newbcast:3 row_mask:0xf bank_mask:0xf
    v_mul_f32_dpp v245, v222, v241 row_newbcast:7 row_mask:0xf bank_mask:0xf
    s_waitcnt vmcnt(7)
    ds_read_b64_tr_b16 v[144:145], v231 offset:4224
    ds_read_b64_tr_b16 v[148:149], v232 offset:4256
    ds_read_b64_tr_b16 v[152:153], v231 offset:4288
    ds_read_b64_tr_b16 v[156:157], v232 offset:4320
    v_mfma_f32_16x16x32_bf16 v[20:23], v[164:167], v[132:135], 0
    v_cvt_pk_bf16_f32 v174, v244, v245
    v_mul_f32_dpp v246, v222, v242 row_newbcast:11 row_mask:0xf bank_mask:0xf
    s_add_u32 m0, s51, 4224
    v_mfma_f32_16x16x32_bf16 v[8:11], v[164:167], v[136:139], 0
    v_mul_f32_dpp v247, v222, v243 row_newbcast:15 row_mask:0xf bank_mask:0xf
    v_cvt_pk_bf16_f32 v175, v246, v247
    s_waitcnt lgkmcnt(0)
    buffer_load_dwordx4 v226, s[4:7], s49 offen sc1 lds
    buffer_load_dwordx4 v227, s[4:7], s49 offen offset:1088 sc1 lds
    v_mfma_f32_16x16x32_bf16 v[12:15], v[164:167], v[140:143], 0
    v_mul_f32_dpp v244, v221, v236 row_newbcast:2 row_mask:0xf bank_mask:0xf
    v_mul_f32_dpp v245, v221, v237 row_newbcast:6 row_mask:0xf bank_mask:0xf
    v_mfma_f32_16x16x32_bf16 v[0:3], v[252:255], v[128:131], 0
    v_cvt_pk_bf16_f32 v168, v244, v245
    v_mul_f32_dpp v246, v221, v238 row_newbcast:10 row_mask:0xf bank_mask:0xf
    v_mfma_f32_16x16x32_bf16 v[4:7], v[252:255], v[132:135], 0
    v_mul_f32_dpp v247, v221, v239 row_newbcast:14 row_mask:0xf bank_mask:0xf
    v_cvt_pk_bf16_f32 v169, v246, v247
    v_mfma_f32_16x16x32_bf16 v[40:43], v[252:255], v[136:139], 0
    v_mul_f32_dpp v244, v221, v240 row_newbcast:3 row_mask:0xf bank_mask:0xf
    v_mul_f32_dpp v245, v221, v241 row_newbcast:7 row_mask:0xf bank_mask:0xf
    v_mfma_f32_16x16x32_bf16 v[44:47], v[252:255], v[140:143], 0
    v_cvt_pk_bf16_f32 v170, v244, v245
    v_mul_f32_dpp v246, v221, v242 row_newbcast:11 row_mask:0xf bank_mask:0xf
    v_mfma_f32_16x16x32_bf16 v[32:35], v[172:175], v[128:131], 0
    v_mul_f32_dpp v247, v221, v243 row_newbcast:15 row_mask:0xf bank_mask:0xf
    v_cvt_pk_bf16_f32 v171, v246, v247
    s_waitcnt vmcnt(7)
    ds_read_b64_tr_b16 v[146:147], v231 offset:0
    ds_read_b64_tr_b16 v[150:151], v232 offset:32
    ds_read_b64_tr_b16 v[154:155], v231 offset:64
    ds_read_b64_tr_b16 v[158:159], v232 offset:96
    v_mfma_f32_16x16x32_bf16 v[36:39], v[172:175], v[132:135], 0
    s_set_gpr_idx_on s45, gpr_idx(SRC1)
    v_mad_u32_u16 v235, 8, v199, 0
    v_lshlrev_b32 v220, 16, v198
    v_and_b32 v221, s100, v198
    v_and_b32 v222, s100, v199
    s_set_gpr_idx_off
    s_add_u32 m0, s51, 0
    v_mfma_f32_16x16x32_bf16 v[72:75], v[172:175], v[136:139], 0
    s_waitcnt lgkmcnt(0)
    buffer_load_dwordx4 v224, s[4:7], s50 offen sc1 lds
    buffer_load_dwordx4 v225, s[4:7], s50 offen offset:1088 sc1 lds
    v_mfma_f32_16x16x32_bf16 v[76:79], v[172:175], v[140:143], 0
    v_xor_b32 v176, s101, v164
    v_xor_b32 v177, s101, v165
    v_mfma_f32_16x16x32_bf16 v[24:27], v[168:171], v[128:131], 0
    v_add_u32_dpp v248, v235, v230 quad_perm:[0,0,0,0] row_mask:0xf bank_mask:0xf
    v_add_u32_dpp v249, v235, v230 quad_perm:[1,1,1,1] row_mask:0xf bank_mask:0xf
    ds_read_b64_tr_b16 v[160:161], v248
    ds_read_b64_tr_b16 v[162:163], v249
    v_mfma_f32_16x16x32_bf16 v[28:31], v[168:171], v[132:135], 0
    v_xor_b32 v178, s101, v166
    v_xor_b32 v179, s101, v167
    v_mfma_f32_16x16x32_bf16 v[80:83], v[168:171], v[136:139], 0
    v_xor_b32 v180, s101, v172
    v_xor_b32 v181, s101, v173
    v_mfma_f32_16x16x32_bf16 v[84:87], v[168:171], v[140:143], 0
    v_xor_b32 v182, s101, v174
    v_xor_b32 v183, s101, v175
    v_mfma_f32_16x16x32_bf16 v[84:87], v[176:179], v[148:151], v[84:87]
    s_waitcnt lgkmcnt(0)
    v_lshlrev_b32 v236, 16, v160
    v_and_b32 v237, s100, v160
    s_waitcnt vmcnt(7)
    ds_read_b64_tr_b16 v[128:129], v231 offset:2112
    ds_read_b64_tr_b16 v[132:133], v232 offset:2144
    ds_read_b64_tr_b16 v[136:137], v231 offset:2176
    ds_read_b64_tr_b16 v[140:141], v232 offset:2208
    v_mfma_f32_16x16x32_bf16 v[80:83], v[176:179], v[144:147], v[80:83]
    v_lshlrev_b32 v238, 16, v161
    v_and_b32 v239, s100, v161
    s_add_u32 m0, s51, 2112
    v_mfma_f32_16x16x32_bf16 v[72:75], v[176:179], v[152:155], v[72:75]
    v_lshlrev_b32 v240, 16, v162
    v_and_b32 v241, s100, v162
    s_waitcnt lgkmcnt(0)
    buffer_load_dwordx4 v226, s[4:7], s50 offen sc1 lds
    buffer_load_dwordx4 v227, s[4:7], s50 offen offset:1088 sc1 lds
    v_mfma_f32_16x16x32_bf16 v[76:79], v[176:179], v[156:159], v[76:79]
    v_lshlrev_b32 v242, 16, v163
    v_and_b32 v243, s100, v163
    v_mfma_f32_16x16x32_bf16 v[48:51], v[252:255], v[144:147], 0
    v_mul_f32_dpp v244, v220, v236 row_newbcast:0 row_mask:0xf bank_mask:0xf
    v_mul_f32_dpp v245, v220, v237 row_newbcast:4 row_mask:0xf bank_mask:0xf
    v_mfma_f32_16x16x32_bf16 v[52:55], v[252:255], v[148:151], 0
    v_cvt_pk_bf16_f32 v164, v244, v245
    v_mfma_f32_16x16x32_bf16 v[56:59], v[252:255], v[152:155], 0
    s_add_u32 s45, s45, 1
    s_cmp_lt_u32 s45, s44
    s_cbranch_scc0 S0f10_w
    s_lshr_b32 s54, s45, 1
    s_set_gpr_idx_on s54, gpr_idx(SRC0)
    v_mov_b32 v223, v188
    s_set_gpr_idx_off
    v_mul_f32_dpp v246, v220, v238 row_newbcast:8 row_mask:0xf bank_mask:0xf
    v_mov_b32_dpp v223, v223 row_shl:4 row_mask:0xf bank_mask:0x5
S0f10_b:
    v_mfma_f32_16x16x32_bf16 v[60:63], v[252:255], v[156:159], 0
    v_mul_f32_dpp v247, v220, v239 row_newbcast:12 row_mask:0xf bank_mask:0xf
    v_cvt_pk_bf16_f32 v165, v246, v247
    v_mfma_f32_16x16x32_bf16 v[8:11], v[168:171], v[144:147], v[8:11]
    v_add_u32_dpp v224, v223, v228 quad_perm:[0,0,0,0] row_mask:0xf bank_mask:0xf
    v_add_u32_dpp v225, v223, v229 quad_perm:[1,1,1,1] row_mask:0xf bank_mask:0xf
    s_waitcnt vmcnt(4)
    ds_read_b64_tr_b16 v[130:131], v231 offset:4224
    ds_read_b64_tr_b16 v[134:135], v232 offset:4256
    ds_read_b64_tr_b16 v[138:139], v231 offset:4288
    ds_read_b64_tr_b16 v[142:143], v232 offset:4320
    v_mfma_f32_16x16x32_bf16 v[8:11], v[172:175], v[152:155], v[8:11]
    v_mul_f32_dpp v244, v220, v240 row_newbcast:1 row_mask:0xf bank_mask:0xf
    v_mul_f32_dpp v245, v220, v241 row_newbcast:5 row_mask:0xf bank_mask:0xf
    s_add_u32 m0, s51, 4224
    v_mfma_f32_16x16x32_bf16 v[12:15], v[168:171], v[148:151], v[12:15]
    v_cvt_pk_bf16_f32 v166, v244, v245
    v_mul_f32_dpp v246, v220, v242 row_newbcast:9 row_mask:0xf bank_mask:0xf
    s_waitcnt lgkmcnt(0)
    buffer_load_dwordx4 v224, s[4:7], s49 offen sc1 lds
    buffer_load_dwordx4 v225, s[4:7], s49 offen offset:1088 sc1 lds
    v_mfma_f32_16x16x32_bf16 v[12:15], v[172:175], v[156:159], v[12:15]
    v_mul_f32_dpp v247, v220, v243 row_newbcast:13 row_mask:0xf bank_mask:0xf
    v_cvt_pk_bf16_f32 v167, v246, v247
    v_mfma_f32_16x16x32_bf16 v[64:67], v[180:183], v[144:147], 0
    v_add_u32_dpp v226, v223, v228 quad_perm:[2,2,2,2] row_mask:0xf bank_mask:0xf
    v_add_u32_dpp v227, v223, v229 quad_perm:[3,3,3,3] row_mask:0xf bank_mask:0xf
    v_mfma_f32_16x16x32_bf16 v[64:67], v[168:171], v[152:155], v[64:67]
    v_mul_f32_dpp v244, v222, v236 row_newbcast:0 row_mask:0xf bank_mask:0xf
    v_mul_f32_dpp v245, v222, v237 row_newbcast:4 row_mask:0xf bank_mask:0xf
    v_mfma_f32_16x16x32_bf16 v[68:71], v[180:183], v[148:151], 0
    v_cvt_pk_bf16_f32 v172, v244, v245
    v_mul_f32_dpp v246, v222, v238 row_newbcast:8 row_mask:0xf bank_mask:0xf
    v_mfma_f32_16x16x32_bf16 v[68:71], v[168:171], v[156:159], v[68:71]
    v_mul_f32_dpp v247, v222, v239 row_newbcast:12 row_mask:0xf bank_mask:0xf
    v_cvt_pk_bf16_f32 v173, v246, v247
    s_sub_u32 s46, s46, 1
    s_cbranch_scc1 EP10
    s_cmp_eq_u32 s45, 0
    s_cbranch_scc1 S1n00
S1n01:
    v_mfma_f32_16x16x32_bf16 v[16:19], v[164:167], v[128:131], v[16:19]
    v_mul_f32_dpp v244, v222, v240 row_newbcast:1 row_mask:0xf bank_mask:0xf
    v_mul_f32_dpp v245, v222, v241 row_newbcast:5 row_mask:0xf bank_mask:0xf
    s_waitcnt vmcnt(4)
    ds_read_b64_tr_b16 v[144:145], v231 offset:0
    ds_read_b64_tr_b16 v[148:149], v232 offset:32
    ds_read_b64_tr_b16 v[152:153], v231 offset:64
    ds_read_b64_tr_b16 v[156:157], v232 offset:96
    v_mfma_f32_16x16x32_bf16 v[20:23], v[164:167], v[132:135], v[20:23]
    v_cvt_pk_bf16_f32 v174, v244, v245
    v_mul_f32_dpp v246, v222, v242 row_newbcast:9 row_mask:0xf bank_mask:0xf
    s_add_u32 m0, s51, 0
    v_mfma_f32_16x16x32_bf16 v[8:11], v[164:167], v[136:139], v[8:11]
    v_mul_f32_dpp v247, v222, v243 row_newbcast:13 row_mask:0xf bank_mask:0xf
    v_cvt_pk_bf16_f32 v175, v246, v247
    s_waitcnt lgkmcnt(0)
    buffer_load_dwordx4 v226, s[4:7], s49 offen sc1 lds
    buffer_load_dwordx4 v227, s[4:7], s49 offen offset:1088 sc1 lds
    v_mfma_f32_16x16x32_bf16 v[12:15], v[164:167], v[140:143], v[12:15]
    v_mul_f32_dpp v244, v221, v236 row_newbcast:0 row_mask:0xf bank_mask:0xf
    v_mul_f32_dpp v245, v221, v237 row_newbcast:4 row_mask:0xf bank_mask:0xf
    v_mfma_f32_16x16x32_bf16 v[0:3], v[160:163], v[128:131], v[0:3]
    v_cvt_pk_bf16_f32 v168, v244, v245
    v_mfma_f32_16x16x32_bf16 v[4:7], v[160:163], v[132:135], v[4:7]
    v_mul_f32_dpp v246, v221, v238 row_newbcast:8 row_mask:0xf bank_mask:0xf
    v_mul_f32_dpp v247, v221, v239 row_newbcast:12 row_mask:0xf bank_mask:0xf
    v_mfma_f32_16x16x32_bf16 v[40:43], v[160:163], v[136:139], v[40:43]
    v_cvt_pk_bf16_f32 v169, v246, v247
    v_mul_f32_dpp v244, v221, v240 row_newbcast:1 row_mask:0xf bank_mask:0xf
    v_mfma_f32_16x16x32_bf16 v[44:47], v[160:163], v[140:143], v[44:47]
    v_mul_f32_dpp v245, v221, v241 row_newbcast:5 row_mask:0xf bank_mask:0xf
    v_cvt_pk_bf16_f32 v170, v244, v245
    v_mfma_f32_16x16x32_bf16 v[32:35], v[172:175], v[128:131], v[32:35]
    v_mul_f32_dpp v246, v221, v242 row_newbcast:9 row_mask:0xf bank_mask:0xf
    v_mul_f32_dpp v247, v221, v243 row_newbcast:13 row_mask:0xf bank_mask:0xf
    s_waitcnt vmcnt(4)
    ds_read_b64_tr_b16 v[146:147], v231 offset:2112
    ds_read_b64_tr_b16 v[150:151], v232 offset:2144
    ds_read_b64_tr_b16 v[154:155], v231 offset:2176
    ds_read_b64_tr_b16 v[158:159], v232 offset:2208
    v_mfma_f32_16x16x32_bf16 v[36:39], v[172:175], v[132:135], v[36:39]
    v_cvt_pk_bf16_f32 v171, v246, v247
    v_xor_b32 v176, s101, v164
    s_add_u32 m0, s51, 2112
    v_mfma_f32_16x16x32_bf16 v[72:75], v[172:175], v[136:139], v[72:75]
    v_xor_b32 v177, s101, v165
    v_add_u32_dpp v248, v235, v230 quad_perm:[2,2,2,2] row_mask:0xf bank_mask:0xf
    s_waitcnt lgkmcnt(0)
    buffer_load_dwordx4 v224, s[4:7], s50 offen sc1 lds
    buffer_load_dwordx4 v225, s[4:7], s50 offen offset:1088 sc1 lds
    v_mfma_f32_16x16x32_bf16 v[76:79], v[172:175], v[140:143], v[76:79]
    v_add_u32_dpp v249, v235, v230 quad_perm:[3,3,3,3] row_mask:0xf bank_mask:0xf
    ds_read_b64_tr_b16 v[252:253], v248
    ds_read_b64_tr_b16 v[254:255], v249
    v_xor_b32 v178, s101, v166
    v_mfma_f32_16x16x32_bf16 v[24:27], v[168:171], v[128:131], v[24:27]
    v_xor_b32 v179, s101, v167
    v_mfma_f32_16x16x32_bf16 v[28:31], v[168:171], v[132:135], v[28:31]
    v_xor_b32 v180, s101, v172
    v_xor_b32 v181, s101, v173
    v_mfma_f32_16x16x32_bf16 v[80:83], v[168:171], v[136:139], v[80:83]
    v_xor_b32 v182, s101, v174
    v_xor_b32 v183, s101, v175
    v_mfma_f32_16x16x32_bf16 v[84:87], v[168:171], v[140:143], v[84:87]
    s_waitcnt lgkmcnt(0)
    v_lshlrev_b32 v236, 16, v252
    v_and_b32 v237, s100, v252
    v_mfma_f32_16x16x32_bf16 v[84:87], v[176:179], v[148:151], v[84:87]
    v_lshlrev_b32 v238, 16, v253
    v_and_b32 v239, s100, v253
    s_waitcnt vmcnt(4)
    ds_read_b64_tr_b16 v[128:129], v231 offset:4224
    ds_read_b64_tr_b16 v[132:133], v232 offset:4256
    ds_read_b64_tr_b16 v[136:137], v231 offset:4288
    ds_read_b64_tr_b16 v[140:141], v232 offset:4320
    v_mfma_f32_16x16x32_bf16 v[80:83], v[176:179], v[144:147], v[80:83]
    v_lshlrev_b32 v240, 16, v254
    v_and_b32 v241, s100, v254
    s_add_u32 m0, s51, 4224
    v_mfma_f32_16x16x32_bf16 v[72:75], v[176:179], v[152:155], v[72:75]
    v_lshlrev_b32 v242, 16, v255
    v_and_b32 v243, s100, v255
    s_waitcnt lgkmcnt(0)
    buffer_load_dwordx4 v226, s[4:7], s50 offen sc1 lds
    buffer_load_dwordx4 v227, s[4:7], s50 offen offset:1088 sc1 lds
    v_mfma_f32_16x16x32_bf16 v[76:79], v[176:179], v[156:159], v[76:79]
    v_mul_f32_dpp v244, v220, v236 row_newbcast:2 row_mask:0xf bank_mask:0xf
    v_mul_f32_dpp v245, v220, v237 row_newbcast:6 row_mask:0xf bank_mask:0xf
    v_mfma_f32_16x16x32_bf16 v[48:51], v[160:163], v[144:147], v[48:51]
    v_cvt_pk_bf16_f32 v164, v244, v245
    v_mfma_f32_16x16x32_bf16 v[52:55], v[160:163], v[148:151], v[52:55]
    s_add_u32 s45, s45, 1
    s_cmp_lt_u32 s45, s44
    s_cbranch_scc0 S1n01_w
S1n01_b:
    s_lshr_b32 s54, s45, 1
    s_set_gpr_idx_on s54, gpr_idx(SRC0)
    v_mov_b32 v223, v188
    s_set_gpr_idx_off
    v_mul_f32_dpp v246, v220, v238 row_newbcast:10 row_mask:0xf bank_mask:0xf
    v_mfma_f32_16x16x32_bf16 v[56:59], v[160:163], v[152:155], v[56:59]
    v_mov_b32_dpp v223, v223 row_shr:4 row_mask:0xf bank_mask:0xa
    v_mul_f32_dpp v247, v220, v239 row_newbcast:14 row_mask:0xf bank_mask:0xf
    v_mfma_f32_16x16x32_bf16 v[60:63], v[160:163], v[156:159], v[60:63]
    v_cvt_pk_bf16_f32 v165, v246, v247
    v_add_u32_dpp v224, v223, v228 quad_perm:[0,0,0,0] row_mask:0xf bank_mask:0xf
    v_mfma_f32_16x16x32_bf16 v[8:11], v[168:171], v[144:147], v[8:11]
    v_add_u32_dpp v225, v223, v229 quad_perm:[1,1,1,1] row_mask:0xf bank_mask:0xf
    v_mul_f32_dpp v244, v220, v240 row_newbcast:3 row_mask:0xf bank_mask:0xf
    s_waitcnt vmcnt(4)
    ds_read_b64_tr_b16 v[130:131], v231 offset:0
    ds_read_b64_tr_b16 v[134:135], v232 offset:32
    ds_read_b64_tr_b16 v[138:139], v231 offset:64
    ds_read_b64_tr_b16 v[142:143], v232 offset:96
    v_mfma_f32_16x16x32_bf16 v[8:11], v[172:175], v[152:155], v[8:11]
    v_mul_f32_dpp v245, v220, v241 row_newbcast:7 row_mask:0xf bank_mask:0xf
    v_cvt_pk_bf16_f32 v166, v244, v245
    s_add_u32 m0, s51, 0
    v_mfma_f32_16x16x32_bf16 v[12:15], v[168:171], v[148:151], v[12:15]
    v_mul_f32_dpp v246, v220, v242 row_newbcast:11 row_mask:0xf bank_mask:0xf
    v_mul_f32_dpp v247, v220, v243 row_newbcast:15 row_mask:0xf bank_mask:0xf
    s_waitcnt lgkmcnt(0)
    buffer_load_dwordx4 v224, s[4:7], s49 offen sc1 lds
    buffer_load_dwordx4 v225, s[4:7], s49 offen offset:1088 sc1 lds
    v_mfma_f32_16x16x32_bf16 v[12:15], v[172:175], v[156:159], v[12:15]
    v_cvt_pk_bf16_f32 v167, v246, v247
    v_add_u32_dpp v226, v223, v228 quad_perm:[2,2,2,2] row_mask:0xf bank_mask:0xf
    v_mfma_f32_16x16x32_bf16 v[64:67], v[180:183], v[144:147], v[64:67]
    v_add_u32_dpp v227, v223, v229 quad_perm:[3,3,3,3] row_mask:0xf bank_mask:0xf
    v_mfma_f32_16x16x32_bf16 v[64:67], v[168:171], v[152:155], v[64:67]
    v_mul_f32_dpp v244, v222, v236 row_newbcast:2 row_mask:0xf bank_mask:0xf
    v_mul_f32_dpp v245, v222, v237 row_newbcast:6 row_mask:0xf bank_mask:0xf
    v_mfma_f32_16x16x32_bf16 v[68:71], v[180:183], v[148:151], v[68:71]
    v_cvt_pk_bf16_f32 v172, v244, v245
    v_mul_f32_dpp v246, v222, v238 row_newbcast:10 row_mask:0xf bank_mask:0xf
    v_mfma_f32_16x16x32_bf16 v[68:71], v[168:171], v[156:159], v[68:71]
    v_mul_f32_dpp v247, v222, v239 row_newbcast:14 row_mask:0xf bank_mask:0xf
    v_cvt_pk_bf16_f32 v173, v246, v247
    s_sub_u32 s46, s46, 1
    s_cbranch_scc0 S2n10
EP21:
    s_setprio 0
    v_mul_f32 v16, v16, v104
    v_mul_f32 v20, v20, v108
    v_fmac_f32 v16, v17, v105
    v_fmac_f32 v20, v21, v109
    v_fmac_f32 v16, v18, v106
    v_fmac_f32 v20, v22, v110
    v_fmac_f32 v16, v19, v107
    v_fmac_f32 v20, v23, v111
    v_cvt_pk_bf16_f32 v146, v16, v20
    v_mul_f32 v0, v0, v88
    v_mul_f32 v4, v4, v92
    v_fmac_f32 v0, v1, v89
    v_fmac_f32 v4, v5, v93
    v_fmac_f32 v0, v2, v90
    v_fmac_f32 v4, v6, v94
    v_fmac_f32 v0, v3, v91
    v_fmac_f32 v4, v7, v95
    v_cvt_pk_bf16_f32 v144, v0, v4
    v_mov_b32 v155, 0
    v_mul_f32 v40, v40, v112
    v_mul_f32 v44, v44, v116
    v_fmac_f32 v40, v41, v113
    v_fmac_f32 v44, v45, v117
    v_fmac_f32 v40, v42, v114
    v_fmac_f32 v44, v46, v118
    v_fmac_f32 v40, v43, v115
    v_fmac_f32 v44, v47, v119
    v_cvt_pk_bf16_f32 v149, v40, v44
    v_mul_f32 v32, v32, v104
    v_mul_f32 v36, v36, v108
    v_fmac_f32 v32, v33, v105
    v_fmac_f32 v36, v37, v109
    v_fmac_f32 v32, v34, v106
    v_fmac_f32 v36, v38, v110
    v_fmac_f32 v32, v35, v107
    v_fmac_f32 v36, v39, v111
    v_cvt_pk_bf16_f32 v148, v32, v36
    v_mul_f32 v24, v24, v104
    v_mul_f32 v28, v28, v108
    v_fmac_f32 v24, v25, v105
    v_fmac_f32 v28, v29, v109
    v_fmac_f32 v24, v26, v106
    v_fmac_f32 v28, v30, v110
    v_fmac_f32 v24, v27, v107
    v_fmac_f32 v28, v31, v111
    v_cvt_pk_bf16_f32 v147, v24, v28
    v_mul_f32 v80, v80, v120
    v_mul_f32 v84, v84, v124
    v_fmac_f32 v80, v81, v121
    v_fmac_f32 v84, v85, v125
    v_fmac_f32 v80, v82, v122
    v_fmac_f32 v84, v86, v126
    v_fmac_f32 v80, v83, v123
    v_fmac_f32 v84, v87, v127
    v_cvt_pk_bf16_f32 v154, -v80, -v84
    v_mul_f32 v72, v72, v120
    v_mul_f32 v76, v76, v124
    v_fmac_f32 v72, v73, v121
    v_fmac_f32 v76, v77, v125
    v_fmac_f32 v72, v74, v122
    v_fmac_f32 v76, v78, v126
    v_fmac_f32 v72, v75, v123
    v_fmac_f32 v76, v79, v127
    v_cvt_pk_bf16_f32 v153, v72, v76
    v_mul_f32 v48, v48, v112
    v_mul_f32 v52, v52, v116
    v_fmac_f32 v48, v49, v113
    v_fmac_f32 v52, v53, v117
    v_fmac_f32 v48, v50, v114
    v_fmac_f32 v52, v54, v118
    v_fmac_f32 v48, v51, v115
    v_fmac_f32 v52, v55, v119
    v_cvt_pk_bf16_f32 v150, v48, v52
    v_mul_f32 v56, v56, v112
    v_mul_f32 v60, v60, v116
    v_fmac_f32 v56, v57, v113
    v_fmac_f32 v60, v61, v117
    v_fmac_f32 v56, v58, v114
    v_fmac_f32 v60, v62, v118
    v_fmac_f32 v56, v59, v115
    v_fmac_f32 v60, v63, v119
    v_cvt_pk_bf16_f32 v151, v56, v60
    v_mul_f32 v8, v8, v96
    v_mul_f32 v12, v12, v100
    v_fmac_f32 v8, v9, v97
    v_fmac_f32 v12, v13, v101
    v_fmac_f32 v8, v10, v98
    v_fmac_f32 v12, v14, v102
    v_fmac_f32 v8, v11, v99
    v_fmac_f32 v12, v15, v103
    v_cvt_pk_bf16_f32 v145, v8, v12
    v_mfma_f32_16x16x32_bf16 v[20:23], v[184:187], v[148:151], 0
    v_mul_f32 v64, v64, v120
    v_mul_f32 v68, v68, v124
    v_fmac_f32 v64, v65, v121
    v_fmac_f32 v68, v69, v125
    v_fmac_f32 v64, v66, v122
    v_fmac_f32 v68, v70, v126
    v_fmac_f32 v64, v67, v123
    v_fmac_f32 v68, v71, v127
    v_cvt_pk_bf16_f32 v152, v64, v68
    s_ashr_i32 s58, s58, 1
    s_bitcmp1_b32 s58, 0
    s_cbranch_scc0 EP21_p
    s_setprio 1
EP21_p:
    s_mul_i32 s55, s47, 784
    v_mfma_f32_16x16x32_bf16 v[16:19], v[184:187], v[144:147], 0
    v_mfma_f32_16x16x32_bf16 v[24:27], v[184:187], v[152:155], 0
    v_cvt_pk_bf16_f32 v65, v20, v21
    s_add_u32 s55, s55, s52
    s_add_u32 s47, s47, 1
    s_cmp_lt_u32 s47, s79
    s_cselect_b32 s56, s47, -2
    s_cselect_b32 s47, s47, s41
    v_readlane_b32 s46, v234, s47
    s_cmp_ge_u32 s56, s59
    buffer_store_dword v65, v233, s[20:23], s55 offen offset:256
    v_cvt_pk_bf16_f32 v64, v16, v17
    v_cvt_pk_bf16_f32 v66, v24, v25
    buffer_store_dword v64, v233, s[20:23], s55 offen offset:0
    buffer_store_dword v66, v233, s[20:23], s55 offen offset:512
    s_cbranch_scc1 EP21_evt
EP21_go:
S2f10:
    v_mfma_f32_16x16x32_bf16 v[16:19], v[164:167], v[128:131], 0
    v_mul_f32_dpp v244, v222, v240 row_newbcast:3 row_mask:0xf bank_mask:0xf
    v_mul_f32_dpp v245, v222, v241 row_newbcast:7 row_mask:0xf bank_mask:0xf
    s_waitcnt vmcnt(7)
    ds_read_b64_tr_b16 v[144:145], v231 offset:2112
    ds_read_b64_tr_b16 v[148:149], v232 offset:2144
    ds_read_b64_tr_b16 v[152:153], v231 offset:2176
    ds_read_b64_tr_b16 v[156:157], v232 offset:2208
    v_mfma_f32_16x16x32_bf16 v[20:23], v[164:167], v[132:135], 0
    v_cvt_pk_bf16_f32 v174, v244, v245
    v_mul_f32_dpp v246, v222, v242 row_newbcast:11 row_mask:0xf bank_mask:0xf
    s_add_u32 m0, s51, 2112
    v_mfma_f32_16x16x32_bf16 v[8:11], v[164:167], v[136:139], 0
    v_mul_f32_dpp v247, v222, v243 row_newbcast:15 row_mask:0xf bank_mask:0xf
    v_cvt_pk_bf16_f32 v175, v246, v247
    s_waitcnt lgkmcnt(0)
    buffer_load_dwordx4 v226, s[4:7], s49 offen sc1 lds
    buffer_load_dwordx4 v227, s[4:7], s49 offen offset:1088 sc1 lds
    v_mfma_f32_16x16x32_bf16 v[12:15], v[164:167], v[140:143], 0
    v_mul_f32_dpp v244, v221, v236 row_newbcast:2 row_mask:0xf bank_mask:0xf
    v_mul_f32_dpp v245, v221, v237 row_newbcast:6 row_mask:0xf bank_mask:0xf
    v_mfma_f32_16x16x32_bf16 v[0:3], v[252:255], v[128:131], 0
    v_cvt_pk_bf16_f32 v168, v244, v245
    v_mul_f32_dpp v246, v221, v238 row_newbcast:10 row_mask:0xf bank_mask:0xf
    v_mfma_f32_16x16x32_bf16 v[4:7], v[252:255], v[132:135], 0
    v_mul_f32_dpp v247, v221, v239 row_newbcast:14 row_mask:0xf bank_mask:0xf
    v_cvt_pk_bf16_f32 v169, v246, v247
    v_mfma_f32_16x16x32_bf16 v[40:43], v[252:255], v[136:139], 0
    v_mul_f32_dpp v244, v221, v240 row_newbcast:3 row_mask:0xf bank_mask:0xf
    v_mul_f32_dpp v245, v221, v241 row_newbcast:7 row_mask:0xf bank_mask:0xf
    v_mfma_f32_16x16x32_bf16 v[44:47], v[252:255], v[140:143], 0
    v_cvt_pk_bf16_f32 v170, v244, v245
    v_mul_f32_dpp v246, v221, v242 row_newbcast:11 row_mask:0xf bank_mask:0xf
    v_mfma_f32_16x16x32_bf16 v[32:35], v[172:175], v[128:131], 0
    v_mul_f32_dpp v247, v221, v243 row_newbcast:15 row_mask:0xf bank_mask:0xf
    v_cvt_pk_bf16_f32 v171, v246, v247
    s_waitcnt vmcnt(7)
    ds_read_b64_tr_b16 v[146:147], v231 offset:4224
    ds_read_b64_tr_b16 v[150:151], v232 offset:4256
    ds_read_b64_tr_b16 v[154:155], v231 offset:4288
    ds_read_b64_tr_b16 v[158:159], v232 offset:4320
    v_mfma_f32_16x16x32_bf16 v[36:39], v[172:175], v[132:135], 0
    s_set_gpr_idx_on s45, gpr_idx(SRC1)
    v_mad_u32_u16 v235, 8, v199, 0
    v_lshlrev_b32 v220, 16, v198
    v_and_b32 v221, s100, v198
    v_and_b32 v222, s100, v199
    s_set_gpr_idx_off
    s_add_u32 m0, s51, 4224
    v_mfma_f32_16x16x32_bf16 v[72:75], v[172:175], v[136:139], 0
    s_waitcnt lgkmcnt(0)
    buffer_load_dwordx4 v224, s[4:7], s50 offen sc1 lds
    buffer_load_dwordx4 v225, s[4:7], s50 offen offset:1088 sc1 lds
    v_mfma_f32_16x16x32_bf16 v[76:79], v[172:175], v[140:143], 0
    v_xor_b32 v176, s101, v164
    v_xor_b32 v177, s101, v165
    v_mfma_f32_16x16x32_bf16 v[24:27], v[168:171], v[128:131], 0
    v_add_u32_dpp v248, v235, v230 quad_perm:[0,0,0,0] row_mask:0xf bank_mask:0xf
    v_add_u32_dpp v249, v235, v230 quad_perm:[1,1,1,1] row_mask:0xf bank_mask:0xf
    ds_read_b64_tr_b16 v[160:161], v248
    ds_read_b64_tr_b16 v[162:163], v249
    v_mfma_f32_16x16x32_bf16 v[28:31], v[168:171], v[132:135], 0
    v_xor_b32 v178, s101, v166
    v_xor_b32 v179, s101, v167
    v_mfma_f32_16x16x32_bf16 v[80:83], v[168:171], v[136:139], 0
    v_xor_b32 v180, s101, v172
    v_xor_b32 v181, s101, v173
    v_mfma_f32_16x16x32_bf16 v[84:87], v[168:171], v[140:143], 0
    v_xor_b32 v182, s101, v174
    v_xor_b32 v183, s101, v175
    v_mfma_f32_16x16x32_bf16 v[84:87], v[176:179], v[148:151], v[84:87]
    s_waitcnt lgkmcnt(0)
    v_lshlrev_b32 v236, 16, v160
    v_and_b32 v237, s100, v160
    s_waitcnt vmcnt(7)
    ds_read_b64_tr_b16 v[128:129], v231 offset:0
    ds_read_b64_tr_b16 v[132:133], v232 offset:32
    ds_read_b64_tr_b16 v[136:137], v231 offset:64
    ds_read_b64_tr_b16 v[140:141], v232 offset:96
    v_mfma_f32_16x16x32_bf16 v[80:83], v[176:179], v[144:147], v[80:83]
    v_lshlrev_b32 v238, 16, v161
    v_and_b32 v239, s100, v161
    s_add_u32 m0, s51, 0
    v_mfma_f32_16x16x32_bf16 v[72:75], v[176:179], v[152:155], v[72:75]
    v_lshlrev_b32 v240, 16, v162
    v_and_b32 v241, s100, v162
    s_waitcnt lgkmcnt(0)
    buffer_load_dwordx4 v226, s[4:7], s50 offen sc1 lds
    buffer_load_dwordx4 v227, s[4:7], s50 offen offset:1088 sc1 lds
    v_mfma_f32_16x16x32_bf16 v[76:79], v[176:179], v[156:159], v[76:79]
    v_lshlrev_b32 v242, 16, v163
    v_and_b32 v243, s100, v163
    v_mfma_f32_16x16x32_bf16 v[48:51], v[252:255], v[144:147], 0
    v_mul_f32_dpp v244, v220, v236 row_newbcast:0 row_mask:0xf bank_mask:0xf
    v_mul_f32_dpp v245, v220, v237 row_newbcast:4 row_mask:0xf bank_mask:0xf
    v_mfma_f32_16x16x32_bf16 v[52:55], v[252:255], v[148:151], 0
    v_cvt_pk_bf16_f32 v164, v244, v245
    v_mfma_f32_16x16x32_bf16 v[56:59], v[252:255], v[152:155], 0
    s_add_u32 s45, s45, 1
    s_cmp_lt_u32 s45, s44
    s_cbranch_scc0 S2f10_w
    s_lshr_b32 s54, s45, 1
    s_set_gpr_idx_on s54, gpr_idx(SRC0)
    v_mov_b32 v223, v188
    s_set_gpr_idx_off
    v_mul_f32_dpp v246, v220, v238 row_newbcast:8 row_mask:0xf bank_mask:0xf
    v_mov_b32_dpp v223, v223 row_shl:4 row_mask:0xf bank_mask:0x5
S2f10_b:
    v_mfma_f32_16x16x32_bf16 v[60:63], v[252:255], v[156:159], 0
    v_mul_f32_dpp v247, v220, v239 row_newbcast:12 row_mask:0xf bank_mask:0xf
    v_cvt_pk_bf16_f32 v165, v246, v247
    v_mfma_f32_16x16x32_bf16 v[8:11], v[168:171], v[144:147], v[8:11]
    v_add_u32_dpp v224, v223, v228 quad_perm:[0,0,0,0] row_mask:0xf bank_mask:0xf
    v_add_u32_dpp v225, v223, v229 quad_perm:[1,1,1,1] row_mask:0xf bank_mask:0xf
    s_waitcnt vmcnt(4)
    ds_read_b64_tr_b16 v[130:131], v231 offset:2112
    ds_read_b64_tr_b16 v[134:135], v232 offset:2144
    ds_read_b64_tr_b16 v[138:139], v231 offset:2176
    ds_read_b64_tr_b16 v[142:143], v232 offset:2208
    v_mfma_f32_16x16x32_bf16 v[8:11], v[172:175], v[152:155], v[8:11]
    v_mul_f32_dpp v244, v220, v240 row_newbcast:1 row_mask:0xf bank_mask:0xf
    v_mul_f32_dpp v245, v220, v241 row_newbcast:5 row_mask:0xf bank_mask:0xf
    s_add_u32 m0, s51, 2112
    v_mfma_f32_16x16x32_bf16 v[12:15], v[168:171], v[148:151], v[12:15]
    v_cvt_pk_bf16_f32 v166, v244, v245
    v_mul_f32_dpp v246, v220, v242 row_newbcast:9 row_mask:0xf bank_mask:0xf
    s_waitcnt lgkmcnt(0)
    buffer_load_dwordx4 v224, s[4:7], s49 offen sc1 lds
    buffer_load_dwordx4 v225, s[4:7], s49 offen offset:1088 sc1 lds
    v_mfma_f32_16x16x32_bf16 v[12:15], v[172:175], v[156:159], v[12:15]
    v_mul_f32_dpp v247, v220, v243 row_newbcast:13 row_mask:0xf bank_mask:0xf
    v_cvt_pk_bf16_f32 v167, v246, v247
    v_mfma_f32_16x16x32_bf16 v[64:67], v[180:183], v[144:147], 0
    v_add_u32_dpp v226, v223, v228 quad_perm:[2,2,2,2] row_mask:0xf bank_mask:0xf
    v_add_u32_dpp v227, v223, v229 quad_perm:[3,3,3,3] row_mask:0xf bank_mask:0xf
    v_mfma_f32_16x16x32_bf16 v[64:67], v[168:171], v[152:155], v[64:67]
    v_mul_f32_dpp v244, v222, v236 row_newbcast:0 row_mask:0xf bank_mask:0xf
    v_mul_f32_dpp v245, v222, v237 row_newbcast:4 row_mask:0xf bank_mask:0xf
    v_mfma_f32_16x16x32_bf16 v[68:71], v[180:183], v[148:151], 0
    v_cvt_pk_bf16_f32 v172, v244, v245
    v_mul_f32_dpp v246, v222, v238 row_newbcast:8 row_mask:0xf bank_mask:0xf
    v_mfma_f32_16x16x32_bf16 v[68:71], v[168:171], v[156:159], v[68:71]
    v_mul_f32_dpp v247, v222, v239 row_newbcast:12 row_mask:0xf bank_mask:0xf
    v_cvt_pk_bf16_f32 v173, v246, v247
    s_sub_u32 s46, s46, 1
    s_cbranch_scc1 EP00
    s_cmp_eq_u32 s45, 0
    s_cbranch_scc1 S0n00
S0n01:
    v_mfma_f32_16x16x32_bf16 v[16:19], v[164:167], v[128:131], v[16:19]
    v_mul_f32_dpp v244, v222, v240 row_newbcast:1 row_mask:0xf bank_mask:0xf
    v_mul_f32_dpp v245, v222, v241 row_newbcast:5 row_mask:0xf bank_mask:0xf
    s_waitcnt vmcnt(4)
    ds_read_b64_tr_b16 v[144:145], v231 offset:4224
    ds_read_b64_tr_b16 v[148:149], v232 offset:4256
    ds_read_b64_tr_b16 v[152:153], v231 offset:4288
    ds_read_b64_tr_b16 v[156:157], v232 offset:4320
    v_mfma_f32_16x16x32_bf16 v[20:23], v[164:167], v[132:135], v[20:23]
    v_cvt_pk_bf16_f32 v174, v244, v245
    v_mul_f32_dpp v246, v222, v242 row_newbcast:9 row_mask:0xf bank_mask:0xf
    s_add_u32 m0, s51, 4224
    v_mfma_f32_16x16x32_bf16 v[8:11], v[164:167], v[136:139], v[8:11]
    v_mul_f32_dpp v247, v222, v243 row_newbcast:13 row_mask:0xf bank_mask:0xf
    v_cvt_pk_bf16_f32 v175, v246, v247
    s_waitcnt lgkmcnt(0)
    buffer_load_dwordx4 v226, s[4:7], s49 offen sc1 lds
    buffer_load_dwordx4 v227, s[4:7], s49 offen offset:1088 sc1 lds
    v_mfma_f32_16x16x32_bf16 v[12:15], v[164:167], v[140:143], v[12:15]
    v_mul_f32_dpp v244, v221, v236 row_newbcast:0 row_mask:0xf bank_mask:0xf
    v_mul_f32_dpp v245, v221, v237 row_newbcast:4 row_mask:0xf bank_mask:0xf
    v_mfma_f32_16x16x32_bf16 v[0:3], v[160:163], v[128:131], v[0:3]
    v_cvt_pk_bf16_f32 v168, v244, v245
    v_mfma_f32_16x16x32_bf16 v[4:7], v[160:163], v[132:135], v[4:7]
    v_mul_f32_dpp v246, v221, v238 row_newbcast:8 row_mask:0xf bank_mask:0xf
    v_mul_f32_dpp v247, v221, v239 row_newbcast:12 row_mask:0xf bank_mask:0xf
    v_mfma_f32_16x16x32_bf16 v[40:43], v[160:163], v[136:139], v[40:43]
    v_cvt_pk_bf16_f32 v169, v246, v247
    v_mul_f32_dpp v244, v221, v240 row_newbcast:1 row_mask:0xf bank_mask:0xf
    v_mfma_f32_16x16x32_bf16 v[44:47], v[160:163], v[140:143], v[44:47]
    v_mul_f32_dpp v245, v221, v241 row_newbcast:5 row_mask:0xf bank_mask:0xf
    v_cvt_pk_bf16_f32 v170, v244, v245
    v_mfma_f32_16x16x32_bf16 v[32:35], v[172:175], v[128:131], v[32:35]
    v_mul_f32_dpp v246, v221, v242 row_newbcast:9 row_mask:0xf bank_mask:0xf
    v_mul_f32_dpp v247, v221, v243 row_newbcast:13 row_mask:0xf bank_mask:0xf
    s_waitcnt vmcnt(4)
    ds_read_b64_tr_b16 v[146:147], v231 offset:0
    ds_read_b64_tr_b16 v[150:151], v232 offset:32
    ds_read_b64_tr_b16 v[154:155], v231 offset:64
    ds_read_b64_tr_b16 v[158:159], v232 offset:96
    v_mfma_f32_16x16x32_bf16 v[36:39], v[172:175], v[132:135], v[36:39]
    v_cvt_pk_bf16_f32 v171, v246, v247
    v_xor_b32 v176, s101, v164
    s_add_u32 m0, s51, 0
    v_mfma_f32_16x16x32_bf16 v[72:75], v[172:175], v[136:139], v[72:75]
    v_xor_b32 v177, s101, v165
    v_add_u32_dpp v248, v235, v230 quad_perm:[2,2,2,2] row_mask:0xf bank_mask:0xf
    s_waitcnt lgkmcnt(0)
    buffer_load_dwordx4 v224, s[4:7], s50 offen sc1 lds
    buffer_load_dwordx4 v225, s[4:7], s50 offen offset:1088 sc1 lds
    v_mfma_f32_16x16x32_bf16 v[76:79], v[172:175], v[140:143], v[76:79]
    v_add_u32_dpp v249, v235, v230 quad_perm:[3,3,3,3] row_mask:0xf bank_mask:0xf
    ds_read_b64_tr_b16 v[252:253], v248
    ds_read_b64_tr_b16 v[254:255], v249
    v_xor_b32 v178, s101, v166
    v_mfma_f32_16x16x32_bf16 v[24:27], v[168:171], v[128:131], v[24:27]
    v_xor_b32 v179, s101, v167
    v_mfma_f32_16x16x32_bf16 v[28:31], v[168:171], v[132:135], v[28:31]
    v_xor_b32 v180, s101, v172
    v_xor_b32 v181, s101, v173
    v_mfma_f32_16x16x32_bf16 v[80:83], v[168:171], v[136:139], v[80:83]
    v_xor_b32 v182, s101, v174
    v_xor_b32 v183, s101, v175
    v_mfma_f32_16x16x32_bf16 v[84:87], v[168:171], v[140:143], v[84:87]
    s_waitcnt lgkmcnt(0)
    v_lshlrev_b32 v236, 16, v252
    v_and_b32 v237, s100, v252
    v_mfma_f32_16x16x32_bf16 v[84:87], v[176:179], v[148:151], v[84:87]
    v_lshlrev_b32 v238, 16, v253
    v_and_b32 v239, s100, v253
    s_waitcnt vmcnt(4)
    ds_read_b64_tr_b16 v[128:129], v231 offset:2112
    ds_read_b64_tr_b16 v[132:133], v232 offset:2144
    ds_read_b64_tr_b16 v[136:137], v231 offset:2176
    ds_read_b64_tr_b16 v[140:141], v232 offset:2208
    v_mfma_f32_16x16x32_bf16 v[80:83], v[176:179], v[144:147], v[80:83]
    v_lshlrev_b32 v240, 16, v254
    v_and_b32 v241, s100, v254
    s_add_u32 m0, s51, 2112
    v_mfma_f32_16x16x32_bf16 v[72:75], v[176:179], v[152:155], v[72:75]
    v_lshlrev_b32 v242, 16, v255
    v_and_b32 v243, s100, v255
    s_waitcnt lgkmcnt(0)
    buffer_load_dwordx4 v226, s[4:7], s50 offen sc1 lds
    buffer_load_dwordx4 v227, s[4:7], s50 offen offset:1088 sc1 lds
    v_mfma_f32_16x16x32_bf16 v[76:79], v[176:179], v[156:159], v[76:79]
    v_mul_f32_dpp v244, v220, v236 row_newbcast:2 row_mask:0xf bank_mask:0xf
    v_mul_f32_dpp v245, v220, v237 row_newbcast:6 row_mask:0xf bank_mask:0xf
    v_mfma_f32_16x16x32_bf16 v[48:51], v[160:163], v[144:147], v[48:51]
    v_cvt_pk_bf16_f32 v164, v244, v245
    v_mfma_f32_16x16x32_bf16 v[52:55], v[160:163], v[148:151], v[52:55]
    s_add_u32 s45, s45, 1
    s_cmp_lt_u32 s45, s44
    s_cbranch_scc0 S0n01_w
S0n01_b:
    s_lshr_b32 s54, s45, 1
    s_set_gpr_idx_on s54, gpr_idx(SRC0)
    v_mov_b32 v223, v188
    s_set_gpr_idx_off
    v_mul_f32_dpp v246, v220, v238 row_newbcast:10 row_mask:0xf bank_mask:0xf
    v_mfma_f32_16x16x32_bf16 v[56:59], v[160:163], v[152:155], v[56:59]
    v_mov_b32_dpp v223, v223 row_shr:4 row_mask:0xf bank_mask:0xa
    v_mul_f32_dpp v247, v220, v239 row_newbcast:14 row_mask:0xf bank_mask:0xf
    v_mfma_f32_16x16x32_bf16 v[60:63], v[160:163], v[156:159], v[60:63]
    v_cvt_pk_bf16_f32 v165, v246, v247
    v_add_u32_dpp v224, v223, v228 quad_perm:[0,0,0,0] row_mask:0xf bank_mask:0xf
    v_mfma_f32_16x16x32_bf16 v[8:11], v[168:171], v[144:147], v[8:11]
    v_add_u32_dpp v225, v223, v229 quad_perm:[1,1,1,1] row_mask:0xf bank_mask:0xf
    v_mul_f32_dpp v244, v220, v240 row_newbcast:3 row_mask:0xf bank_mask:0xf
    s_waitcnt vmcnt(4)
    ds_read_b64_tr_b16 v[130:131], v231 offset:4224
    ds_read_b64_tr_b16 v[134:135], v232 offset:4256
    ds_read_b64_tr_b16 v[138:139], v231 offset:4288
    ds_read_b64_tr_b16 v[142:143], v232 offset:4320
    v_mfma_f32_16x16x32_bf16 v[8:11], v[172:175], v[152:155], v[8:11]
    v_mul_f32_dpp v245, v220, v241 row_newbcast:7 row_mask:0xf bank_mask:0xf
    v_cvt_pk_bf16_f32 v166, v244, v245
    s_add_u32 m0, s51, 4224
    v_mfma_f32_16x16x32_bf16 v[12:15], v[168:171], v[148:151], v[12:15]
    v_mul_f32_dpp v246, v220, v242 row_newbcast:11 row_mask:0xf bank_mask:0xf
    v_mul_f32_dpp v247, v220, v243 row_newbcast:15 row_mask:0xf bank_mask:0xf
    s_waitcnt lgkmcnt(0)
    buffer_load_dwordx4 v224, s[4:7], s49 offen sc1 lds
    buffer_load_dwordx4 v225, s[4:7], s49 offen offset:1088 sc1 lds
    v_mfma_f32_16x16x32_bf16 v[12:15], v[172:175], v[156:159], v[12:15]
    v_cvt_pk_bf16_f32 v167, v246, v247
    v_add_u32_dpp v226, v223, v228 quad_perm:[2,2,2,2] row_mask:0xf bank_mask:0xf
    v_mfma_f32_16x16x32_bf16 v[64:67], v[180:183], v[144:147], v[64:67]
    v_add_u32_dpp v227, v223, v229 quad_perm:[3,3,3,3] row_mask:0xf bank_mask:0xf
    v_mfma_f32_16x16x32_bf16 v[64:67], v[168:171], v[152:155], v[64:67]
    v_mul_f32_dpp v244, v222, v236 row_newbcast:2 row_mask:0xf bank_mask:0xf
    v_mul_f32_dpp v245, v222, v237 row_newbcast:6 row_mask:0xf bank_mask:0xf
    v_mfma_f32_16x16x32_bf16 v[68:71], v[180:183], v[148:151], v[68:71]
    v_cvt_pk_bf16_f32 v172, v244, v245
    v_mul_f32_dpp v246, v222, v238 row_newbcast:10 row_mask:0xf bank_mask:0xf
    v_mfma_f32_16x16x32_bf16 v[68:71], v[168:171], v[156:159], v[68:71]
    v_mul_f32_dpp v247, v222, v239 row_newbcast:14 row_mask:0xf bank_mask:0xf
    v_cvt_pk_bf16_f32 v173, v246, v247
    s_sub_u32 s46, s46, 1
    s_cbranch_scc0 S1n10
EP11:
    s_setprio 0
    v_mul_f32 v16, v16, v104
    v_mul_f32 v20, v20, v108
    v_fmac_f32 v16, v17, v105
    v_fmac_f32 v20, v21, v109
    v_fmac_f32 v16, v18, v106
    v_fmac_f32 v20, v22, v110
    v_fmac_f32 v16, v19, v107
    v_fmac_f32 v20, v23, v111
    v_cvt_pk_bf16_f32 v146, v16, v20
    v_mul_f32 v0, v0, v88
    v_mul_f32 v4, v4, v92
    v_fmac_f32 v0, v1, v89
    v_fmac_f32 v4, v5, v93
    v_fmac_f32 v0, v2, v90
    v_fmac_f32 v4, v6, v94
    v_fmac_f32 v0, v3, v91
    v_fmac_f32 v4, v7, v95
    v_cvt_pk_bf16_f32 v144, v0, v4
    v_mov_b32 v155, 0
    v_mul_f32 v40, v40, v112
    v_mul_f32 v44, v44, v116
    v_fmac_f32 v40, v41, v113
    v_fmac_f32 v44, v45, v117
    v_fmac_f32 v40, v42, v114
    v_fmac_f32 v44, v46, v118
    v_fmac_f32 v40, v43, v115
    v_fmac_f32 v44, v47, v119
    v_cvt_pk_bf16_f32 v149, v40, v44
    v_mul_f32 v32, v32, v104
    v_mul_f32 v36, v36, v108
    v_fmac_f32 v32, v33, v105
    v_fmac_f32 v36, v37, v109
    v_fmac_f32 v32, v34, v106
    v_fmac_f32 v36, v38, v110
    v_fmac_f32 v32, v35, v107
    v_fmac_f32 v36, v39, v111
    v_cvt_pk_bf16_f32 v148, v32, v36
    v_mul_f32 v24, v24, v104
    v_mul_f32 v28, v28, v108
    v_fmac_f32 v24, v25, v105
    v_fmac_f32 v28, v29, v109
    v_fmac_f32 v24, v26, v106
    v_fmac_f32 v28, v30, v110
    v_fmac_f32 v24, v27, v107
    v_fmac_f32 v28, v31, v111
    v_cvt_pk_bf16_f32 v147, v24, v28
    v_mul_f32 v80, v80, v120
    v_mul_f32 v84, v84, v124
    v_fmac_f32 v80, v81, v121
    v_fmac_f32 v84, v85, v125
    v_fmac_f32 v80, v82, v122
    v_fmac_f32 v84, v86, v126
    v_fmac_f32 v80, v83, v123
    v_fmac_f32 v84, v87, v127
    v_cvt_pk_bf16_f32 v154, -v80, -v84
    v_mul_f32 v72, v72, v120
    v_mul_f32 v76, v76, v124
    v_fmac_f32 v72, v73, v121
    v_fmac_f32 v76, v77, v125
    v_fmac_f32 v72, v74, v122
    v_fmac_f32 v76, v78, v126
    v_fmac_f32 v72, v75, v123
    v_fmac_f32 v76, v79, v127
    v_cvt_pk_bf16_f32 v153, v72, v76
    v_mul_f32 v48, v48, v112
    v_mul_f32 v52, v52, v116
    v_fmac_f32 v48, v49, v113
    v_fmac_f32 v52, v53, v117
    v_fmac_f32 v48, v50, v114
    v_fmac_f32 v52, v54, v118
    v_fmac_f32 v48, v51, v115
    v_fmac_f32 v52, v55, v119
    v_cvt_pk_bf16_f32 v150, v48, v52
    v_mul_f32 v56, v56, v112
    v_mul_f32 v60, v60, v116
    v_fmac_f32 v56, v57, v113
    v_fmac_f32 v60, v61, v117
    v_fmac_f32 v56, v58, v114
    v_fmac_f32 v60, v62, v118
    v_fmac_f32 v56, v59, v115
    v_fmac_f32 v60, v63, v119
    v_cvt_pk_bf16_f32 v151, v56, v60
    v_mul_f32 v8, v8, v96
    v_mul_f32 v12, v12, v100
    v_fmac_f32 v8, v9, v97
    v_fmac_f32 v12, v13, v101
    v_fmac_f32 v8, v10, v98
    v_fmac_f32 v12, v14, v102
    v_fmac_f32 v8, v11, v99
    v_fmac_f32 v12, v15, v103
    v_cvt_pk_bf16_f32 v145, v8, v12
    v_mfma_f32_16x16x32_bf16 v[20:23], v[184:187], v[148:151], 0
    v_mul_f32 v64, v64, v120
    v_mul_f32 v68, v68, v124
    v_fmac_f32 v64, v65, v121
    v_fmac_f32 v68, v69, v125
    v_fmac_f32 v64, v66, v122
    v_fmac_f32 v68, v70, v126
    v_fmac_f32 v64, v67, v123
    v_fmac_f32 v68, v71, v127
    v_cvt_pk_bf16_f32 v152, v64, v68
    s_ashr_i32 s58, s58, 1
    s_bitcmp1_b32 s58, 0
    s_cbranch_scc0 EP11_p
    s_setprio 1
EP11_p:
    s_mul_i32 s55, s47, 784
    v_mfma_f32_16x16x32_bf16 v[16:19], v[184:187], v[144:147], 0
    v_mfma_f32_16x16x32_bf16 v[24:27], v[184:187], v[152:155], 0
    v_cvt_pk_bf16_f32 v65, v20, v21
    s_add_u32 s55, s55, s52
    s_add_u32 s47, s47, 1
    s_cmp_lt_u32 s47, s79
    s_cselect_b32 s56, s47, -2
    s_cselect_b32 s47, s47, s41
    v_readlane_b32 s46, v234, s47
    s_cmp_ge_u32 s56, s59
    buffer_store_dword v65, v233, s[20:23], s55 offen offset:256
    v_cvt_pk_bf16_f32 v64, v16, v17
    v_cvt_pk_bf16_f32 v66, v24, v25
    buffer_store_dword v64, v233, s[20:23], s55 offen offset:0
    buffer_store_dword v66, v233, s[20:23], s55 offen offset:512
    s_cbranch_scc1 EP11_evt
EP11_go:
S1f10:
    v_mfma_f32_16x16x32_bf16 v[16:19], v[164:167], v[128:131], 0
    v_mul_f32_dpp v244, v222, v240 row_newbcast:3 row_mask:0xf bank_mask:0xf
    v_mul_f32_dpp v245, v222, v241 row_newbcast:7 row_mask:0xf bank_mask:0xf
    s_waitcnt vmcnt(7)
    ds_read_b64_tr_b16 v[144:145], v231 offset:0
    ds_read_b64_tr_b16 v[148:149], v232 offset:32
    ds_read_b64_tr_b16 v[152:153], v231 offset:64
    ds_read_b64_tr_b16 v[156:157], v232 offset:96
    v_mfma_f32_16x16x32_bf16 v[20:23], v[164:167], v[132:135], 0
    v_cvt_pk_bf16_f32 v174, v244, v245
    v_mul_f32_dpp v246, v222, v242 row_newbcast:11 row_mask:0xf bank_mask:0xf
    s_add_u32 m0, s51, 0
    v_mfma_f32_16x16x32_bf16 v[8:11], v[164:167], v[136:139], 0
    v_mul_f32_dpp v247, v222, v243 row_newbcast:15 row_mask:0xf bank_mask:0xf
    v_cvt_pk_bf16_f32 v175, v246, v247
    s_waitcnt lgkmcnt(0)
    buffer_load_dwordx4 v226, s[4:7], s49 offen sc1 lds
    buffer_load_dwordx4 v227, s[4:7], s49 offen offset:1088 sc1 lds
    v_mfma_f32_16x16x32_bf16 v[12:15], v[164:167], v[140:143], 0
    v_mul_f32_dpp v244, v221, v236 row_newbcast:2 row_mask:0xf bank_mask:0xf
    v_mul_f32_dpp v245, v221, v237 row_newbcast:6 row_mask:0xf bank_mask:0xf
    v_mfma_f32_16x16x32_bf16 v[0:3], v[252:255], v[128:131], 0
    v_cvt_pk_bf16_f32 v168, v244, v245
    v_mul_f32_dpp v246, v221, v238 row_newbcast:10 row_mask:0xf bank_mask:0xf
    v_mfma_f32_16x16x32_bf16 v[4:7], v[252:255], v[132:135], 0
    v_mul_f32_dpp v247, v221, v239 row_newbcast:14 row_mask:0xf bank_mask:0xf
    v_cvt_pk_bf16_f32 v169, v246, v247
    v_mfma_f32_16x16x32_bf16 v[40:43], v[252:255], v[136:139], 0
    v_mul_f32_dpp v244, v221, v240 row_newbcast:3 row_mask:0xf bank_mask:0xf
    v_mul_f32_dpp v245, v221, v241 row_newbcast:7 row_mask:0xf bank_mask:0xf
    v_mfma_f32_16x16x32_bf16 v[44:47], v[252:255], v[140:143], 0
    v_cvt_pk_bf16_f32 v170, v244, v245
    v_mul_f32_dpp v246, v221, v242 row_newbcast:11 row_mask:0xf bank_mask:0xf
    v_mfma_f32_16x16x32_bf16 v[32:35], v[172:175], v[128:131], 0
    v_mul_f32_dpp v247, v221, v243 row_newbcast:15 row_mask:0xf bank_mask:0xf
    v_cvt_pk_bf16_f32 v171, v246, v247
    s_waitcnt vmcnt(7)
    ds_read_b64_tr_b16 v[146:147], v231 offset:2112
    ds_read_b64_tr_b16 v[150:151], v232 offset:2144
    ds_read_b64_tr_b16 v[154:155], v231 offset:2176
    ds_read_b64_tr_b16 v[158:159], v232 offset:2208
    v_mfma_f32_16x16x32_bf16 v[36:39], v[172:175], v[132:135], 0
    s_set_gpr_idx_on s45, gpr_idx(SRC1)
    v_mad_u32_u16 v235, 8, v199, 0
    v_lshlrev_b32 v220, 16, v198
    v_and_b32 v221, s100, v198
    v_and_b32 v222, s100, v199
    s_set_gpr_idx_off
    s_add_u32 m0, s51, 2112
    v_mfma_f32_16x16x32_bf16 v[72:75], v[172:175], v[136:139], 0
    s_waitcnt lgkmcnt(0)
    buffer_load_dwordx4 v224, s[4:7], s50 offen sc1 lds
    buffer_load_dwordx4 v225, s[4:7], s50 offen offset:1088 sc1 lds
    v_mfma_f32_16x16x32_bf16 v[76:79], v[172:175], v[140:143], 0
    v_xor_b32 v176, s101, v164
    v_xor_b32 v177, s101, v165
    v_mfma_f32_16x16x32_bf16 v[24:27], v[168:171], v[128:131], 0
    v_add_u32_dpp v248, v235, v230 quad_perm:[0,0,0,0] row_mask:0xf bank_mask:0xf
    v_add_u32_dpp v249, v235, v230 quad_perm:[1,1,1,1] row_mask:0xf bank_mask:0xf
    ds_read_b64_tr_b16 v[160:161], v248
    ds_read_b64_tr_b16 v[162:163], v249
    v_mfma_f32_16x16x32_bf16 v[28:31], v[168:171], v[132:135], 0
    v_xor_b32 v178, s101, v166
    v_xor_b32 v179, s101, v167
    v_mfma_f32_16x16x32_bf16 v[80:83], v[168:171], v[136:139], 0
    v_xor_b32 v180, s101, v172
    v_xor_b32 v181, s101, v173
    v_mfma_f32_16x16x32_bf16 v[84:87], v[168:171], v[140:143], 0
    v_xor_b32 v182, s101, v174
    v_xor_b32 v183, s101, v175
    v_mfma_f32_16x16x32_bf16 v[84:87], v[176:179], v[148:151], v[84:87]
    s_waitcnt lgkmcnt(0)
    v_lshlrev_b32 v236, 16, v160
    v_and_b32 v237, s100, v160
    s_waitcnt vmcnt(7)
    ds_read_b64_tr_b16 v[128:129], v231 offset:4224
    ds_read_b64_tr_b16 v[132:133], v232 offset:4256
    ds_read_b64_tr_b16 v[136:137], v231 offset:4288
    ds_read_b64_tr_b16 v[140:141], v232 offset:4320
    v_mfma_f32_16x16x32_bf16 v[80:83], v[176:179], v[144:147], v[80:83]
    v_lshlrev_b32 v238, 16, v161
    v_and_b32 v239, s100, v161
    s_add_u32 m0, s51, 4224
    v_mfma_f32_16x16x32_bf16 v[72:75], v[176:179], v[152:155], v[72:75]
    v_lshlrev_b32 v240, 16, v162
    v_and_b32 v241, s100, v162
    s_waitcnt lgkmcnt(0)
    buffer_load_dwordx4 v226, s[4:7], s50 offen sc1 lds
    buffer_load_dwordx4 v227, s[4:7], s50 offen offset:1088 sc1 lds
    v_mfma_f32_16x16x32_bf16 v[76:79], v[176:179], v[156:159], v[76:79]
    v_lshlrev_b32 v242, 16, v163
    v_and_b32 v243, s100, v163
    v_mfma_f32_16x16x32_bf16 v[48:51], v[252:255], v[144:147], 0
    v_mul_f32_dpp v244, v220, v236 row_newbcast:0 row_mask:0xf bank_mask:0xf
    v_mul_f32_dpp v245, v220, v237 row_newbcast:4 row_mask:0xf bank_mask:0xf
    v_mfma_f32_16x16x32_bf16 v[52:55], v[252:255], v[148:151], 0
    v_cvt_pk_bf16_f32 v164, v244, v245
    v_mfma_f32_16x16x32_bf16 v[56:59], v[252:255], v[152:155], 0
    s_add_u32 s45, s45, 1
    s_cmp_lt_u32 s45, s44
    s_cbranch_scc0 S1f10_w
    s_lshr_b32 s54, s45, 1
    s_set_gpr_idx_on s54, gpr_idx(SRC0)
    v_mov_b32 v223, v188
    s_set_gpr_idx_off
    v_mul_f32_dpp v246, v220, v238 row_newbcast:8 row_mask:0xf bank_mask:0xf
    v_mov_b32_dpp v223, v223 row_shl:4 row_mask:0xf bank_mask:0x5
S1f10_b:
    v_mfma_f32_16x16x32_bf16 v[60:63], v[252:255], v[156:159], 0
    v_mul_f32_dpp v247, v220, v239 row_newbcast:12 row_mask:0xf bank_mask:0xf
    v_cvt_pk_bf16_f32 v165, v246, v247
    v_mfma_f32_16x16x32_bf16 v[8:11], v[168:171], v[144:147], v[8:11]
    v_add_u32_dpp v224, v223, v228 quad_perm:[0,0,0,0] row_mask:0xf bank_mask:0xf
    v_add_u32_dpp v225, v223, v229 quad_perm:[1,1,1,1] row_mask:0xf bank_mask:0xf
    s_waitcnt vmcnt(4)
    ds_read_b64_tr_b16 v[130:131], v231 offset:0
    ds_read_b64_tr_b16 v[134:135], v232 offset:32
    ds_read_b64_tr_b16 v[138:139], v231 offset:64
    ds_read_b64_tr_b16 v[142:143], v232 offset:96
    v_mfma_f32_16x16x32_bf16 v[8:11], v[172:175], v[152:155], v[8:11]
    v_mul_f32_dpp v244, v220, v240 row_newbcast:1 row_mask:0xf bank_mask:0xf
    v_mul_f32_dpp v245, v220, v241 row_newbcast:5 row_mask:0xf bank_mask:0xf
    s_add_u32 m0, s51, 0
    v_mfma_f32_16x16x32_bf16 v[12:15], v[168:171], v[148:151], v[12:15]
    v_cvt_pk_bf16_f32 v166, v244, v245
    v_mul_f32_dpp v246, v220, v242 row_newbcast:9 row_mask:0xf bank_mask:0xf
    s_waitcnt lgkmcnt(0)
    buffer_load_dwordx4 v224, s[4:7], s49 offen sc1 lds
    buffer_load_dwordx4 v225, s[4:7], s49 offen offset:1088 sc1 lds
    v_mfma_f32_16x16x32_bf16 v[12:15], v[172:175], v[156:159], v[12:15]
    v_mul_f32_dpp v247, v220, v243 row_newbcast:13 row_mask:0xf bank_mask:0xf
    v_cvt_pk_bf16_f32 v167, v246, v247
    v_mfma_f32_16x16x32_bf16 v[64:67], v[180:183], v[144:147], 0
    v_add_u32_dpp v226, v223, v228 quad_perm:[2,2,2,2] row_mask:0xf bank_mask:0xf
    v_add_u32_dpp v227, v223, v229 quad_perm:[3,3,3,3] row_mask:0xf bank_mask:0xf
    v_mfma_f32_16x16x32_bf16 v[64:67], v[168:171], v[152:155], v[64:67]
    v_mul_f32_dpp v244, v222, v236 row_newbcast:0 row_mask:0xf bank_mask:0xf
    v_mul_f32_dpp v245, v222, v237 row_newbcast:4 row_mask:0xf bank_mask:0xf
    v_mfma_f32_16x16x32_bf16 v[68:71], v[180:183], v[148:151], 0
    v_cvt_pk_bf16_f32 v172, v244, v245
    v_mul_f32_dpp v246, v222, v238 row_newbcast:8 row_mask:0xf bank_mask:0xf
    v_mfma_f32_16x16x32_bf16 v[68:71], v[168:171], v[156:159], v[68:71]
    v_mul_f32_dpp v247, v222, v239 row_newbcast:12 row_mask:0xf bank_mask:0xf
    v_cvt_pk_bf16_f32 v173, v246, v247
    s_sub_u32 s46, s46, 1
    s_cbranch_scc1 EP20
    s_cmp_eq_u32 s45, 0
    s_cbranch_scc1 S2n00
S2n01:
    v_mfma_f32_16x16x32_bf16 v[16:19], v[164:167], v[128:131], v[16:19]
    v_mul_f32_dpp v244, v222, v240 row_newbcast:1 row_mask:0xf bank_mask:0xf
    v_mul_f32_dpp v245, v222, v241 row_newbcast:5 row_mask:0xf bank_mask:0xf
    s_waitcnt vmcnt(4)
    ds_read_b64_tr_b16 v[144:145], v231 offset:2112
    ds_read_b64_tr_b16 v[148:149], v232 offset:2144
    ds_read_b64_tr_b16 v[152:153], v231 offset:2176
    ds_read_b64_tr_b16 v[156:157], v232 offset:2208
    v_mfma_f32_16x16x32_bf16 v[20:23], v[164:167], v[132:135], v[20:23]
    v_cvt_pk_bf16_f32 v174, v244, v245
    v_mul_f32_dpp v246, v222, v242 row_newbcast:9 row_mask:0xf bank_mask:0xf
    s_add_u32 m0, s51, 2112
    v_mfma_f32_16x16x32_bf16 v[8:11], v[164:167], v[136:139], v[8:11]
    v_mul_f32_dpp v247, v222, v243 row_newbcast:13 row_mask:0xf bank_mask:0xf
    v_cvt_pk_bf16_f32 v175, v246, v247
    s_waitcnt lgkmcnt(0)
    buffer_load_dwordx4 v226, s[4:7], s49 offen sc1 lds
    buffer_load_dwordx4 v227, s[4:7], s49 offen offset:1088 sc1 lds
    v_mfma_f32_16x16x32_bf16 v[12:15], v[164:167], v[140:143], v[12:15]
    v_mul_f32_dpp v244, v221, v236 row_newbcast:0 row_mask:0xf bank_mask:0xf
    v_mul_f32_dpp v245, v221, v237 row_newbcast:4 row_mask:0xf bank_mask:0xf
    v_mfma_f32_16x16x32_bf16 v[0:3], v[160:163], v[128:131], v[0:3]
    v_cvt_pk_bf16_f32 v168, v244, v245
    v_mfma_f32_16x16x32_bf16 v[4:7], v[160:163], v[132:135], v[4:7]
    v_mul_f32_dpp v246, v221, v238 row_newbcast:8 row_mask:0xf bank_mask:0xf
    v_mul_f32_dpp v247, v221, v239 row_newbcast:12 row_mask:0xf bank_mask:0xf
    v_mfma_f32_16x16x32_bf16 v[40:43], v[160:163], v[136:139], v[40:43]
    v_cvt_pk_bf16_f32 v169, v246, v247
    v_mul_f32_dpp v244, v221, v240 row_newbcast:1 row_mask:0xf bank_mask:0xf
    v_mfma_f32_16x16x32_bf16 v[44:47], v[160:163], v[140:143], v[44:47]
    v_mul_f32_dpp v245, v221, v241 row_newbcast:5 row_mask:0xf bank_mask:0xf
    v_cvt_pk_bf16_f32 v170, v244, v245
    v_mfma_f32_16x16x32_bf16 v[32:35], v[172:175], v[128:131], v[32:35]
    v_mul_f32_dpp v246, v221, v242 row_newbcast:9 row_mask:0xf bank_mask:0xf
    v_mul_f32_dpp v247, v221, v243 row_newbcast:13 row_mask:0xf bank_mask:0xf
    s_waitcnt vmcnt(4)
    ds_read_b64_tr_b16 v[146:147], v231 offset:4224
    ds_read_b64_tr_b16 v[150:151], v232 offset:4256
    ds_read_b64_tr_b16 v[154:155], v231 offset:4288
    ds_read_b64_tr_b16 v[158:159], v232 offset:4320
    v_mfma_f32_16x16x32_bf16 v[36:39], v[172:175], v[132:135], v[36:39]
    v_cvt_pk_bf16_f32 v171, v246, v247
    v_xor_b32 v176, s101, v164
    s_add_u32 m0, s51, 4224
    v_mfma_f32_16x16x32_bf16 v[72:75], v[172:175], v[136:139], v[72:75]
    v_xor_b32 v177, s101, v165
    v_add_u32_dpp v248, v235, v230 quad_perm:[2,2,2,2] row_mask:0xf bank_mask:0xf
    s_waitcnt lgkmcnt(0)
    buffer_load_dwordx4 v224, s[4:7], s50 offen sc1 lds
    buffer_load_dwordx4 v225, s[4:7], s50 offen offset:1088 sc1 lds
    v_mfma_f32_16x16x32_bf16 v[76:79], v[172:175], v[140:143], v[76:79]
    v_add_u32_dpp v249, v235, v230 quad_perm:[3,3,3,3] row_mask:0xf bank_mask:0xf
    ds_read_b64_tr_b16 v[252:253], v248
    ds_read_b64_tr_b16 v[254:255], v249
    v_xor_b32 v178, s101, v166
    v_mfma_f32_16x16x32_bf16 v[24:27], v[168:171], v[128:131], v[24:27]
    v_xor_b32 v179, s101, v167
    v_mfma_f32_16x16x32_bf16 v[28:31], v[168:171], v[132:135], v[28:31]
    v_xor_b32 v180, s101, v172
    v_xor_b32 v181, s101, v173
    v_mfma_f32_16x16x32_bf16 v[80:83], v[168:171], v[136:139], v[80:83]
    v_xor_b32 v182, s101, v174
    v_xor_b32 v183, s101, v175
    v_mfma_f32_16x16x32_bf16 v[84:87], v[168:171], v[140:143], v[84:87]
    s_waitcnt lgkmcnt(0)
    v_lshlrev_b32 v236, 16, v252
    v_and_b32 v237, s100, v252
    v_mfma_f32_16x16x32_bf16 v[84:87], v[176:179], v[148:151], v[84:87]
    v_lshlrev_b32 v238, 16, v253
    v_and_b32 v239, s100, v253
    s_waitcnt vmcnt(4)
    ds_read_b64_tr_b16 v[128:129], v231 offset:0
    ds_read_b64_tr_b16 v[132:133], v232 offset:32
    ds_read_b64_tr_b16 v[136:137], v231 offset:64
    ds_read_b64_tr_b16 v[140:141], v232 offset:96
    v_mfma_f32_16x16x32_bf16 v[80:83], v[176:179], v[144:147], v[80:83]
    v_lshlrev_b32 v240, 16, v254
    v_and_b32 v241, s100, v254
    s_add_u32 m0, s51, 0
    v_mfma_f32_16x16x32_bf16 v[72:75], v[176:179], v[152:155], v[72:75]
    v_lshlrev_b32 v242, 16, v255
    v_and_b32 v243, s100, v255
    s_waitcnt lgkmcnt(0)
    buffer_load_dwordx4 v226, s[4:7], s50 offen sc1 lds
    buffer_load_dwordx4 v227, s[4:7], s50 offen offset:1088 sc1 lds
    v_mfma_f32_16x16x32_bf16 v[76:79], v[176:179], v[156:159], v[76:79]
    v_mul_f32_dpp v244, v220, v236 row_newbcast:2 row_mask:0xf bank_mask:0xf
    v_mul_f32_dpp v245, v220, v237 row_newbcast:6 row_mask:0xf bank_mask:0xf
    v_mfma_f32_16x16x32_bf16 v[48:51], v[160:163], v[144:147], v[48:51]
    v_cvt_pk_bf16_f32 v164, v244, v245
    v_mfma_f32_16x16x32_bf16 v[52:55], v[160:163], v[148:151], v[52:55]
    s_add_u32 s45, s45, 1
    s_cmp_lt_u32 s45, s44
    s_cbranch_scc0 S2n01_w
S2n01_b:
    s_lshr_b32 s54, s45, 1
    s_set_gpr_idx_on s54, gpr_idx(SRC0)
    v_mov_b32 v223, v188
    s_set_gpr_idx_off
    v_mul_f32_dpp v246, v220, v238 row_newbcast:10 row_mask:0xf bank_mask:0xf
    v_mfma_f32_16x16x32_bf16 v[56:59], v[160:163], v[152:155], v[56:59]
    v_mov_b32_dpp v223, v223 row_shr:4 row_mask:0xf bank_mask:0xa
    v_mul_f32_dpp v247, v220, v239 row_newbcast:14 row_mask:0xf bank_mask:0xf
    v_mfma_f32_16x16x32_bf16 v[60:63], v[160:163], v[156:159], v[60:63]
    v_cvt_pk_bf16_f32 v165, v246, v247
    v_add_u32_dpp v224, v223, v228 quad_perm:[0,0,0,0] row_mask:0xf bank_mask:0xf
    v_mfma_f32_16x16x32_bf16 v[8:11], v[168:171], v[144:147], v[8:11]
    v_add_u32_dpp v225, v223, v229 quad_perm:[1,1,1,1] row_mask:0xf bank_mask:0xf
    v_mul_f32_dpp v244, v220, v240 row_newbcast:3 row_mask:0xf bank_mask:0xf
    s_waitcnt vmcnt(4)
    ds_read_b64_tr_b16 v[130:131], v231 offset:2112
    ds_read_b64_tr_b16 v[134:135], v232 offset:2144
    ds_read_b64_tr_b16 v[138:139], v231 offset:2176
    ds_read_b64_tr_b16 v[142:143], v232 offset:2208
    v_mfma_f32_16x16x32_bf16 v[8:11], v[172:175], v[152:155], v[8:11]
    v_mul_f32_dpp v245, v220, v241 row_newbcast:7 row_mask:0xf bank_mask:0xf
    v_cvt_pk_bf16_f32 v166, v244, v245
    s_add_u32 m0, s51, 2112
    v_mfma_f32_16x16x32_bf16 v[12:15], v[168:171], v[148:151], v[12:15]
    v_mul_f32_dpp v246, v220, v242 row_newbcast:11 row_mask:0xf bank_mask:0xf
    v_mul_f32_dpp v247, v220, v243 row_newbcast:15 row_mask:0xf bank_mask:0xf
    s_waitcnt lgkmcnt(0)
    buffer_load_dwordx4 v224, s[4:7], s49 offen sc1 lds
    buffer_load_dwordx4 v225, s[4:7], s49 offen offset:1088 sc1 lds
    v_mfma_f32_16x16x32_bf16 v[12:15], v[172:175], v[156:159], v[12:15]
    v_cvt_pk_bf16_f32 v167, v246, v247
    v_add_u32_dpp v226, v223, v228 quad_perm:[2,2,2,2] row_mask:0xf bank_mask:0xf
    v_mfma_f32_16x16x32_bf16 v[64:67], v[180:183], v[144:147], v[64:67]
    v_add_u32_dpp v227, v223, v229 quad_perm:[3,3,3,3] row_mask:0xf bank_mask:0xf
    v_mfma_f32_16x16x32_bf16 v[64:67], v[168:171], v[152:155], v[64:67]
    v_mul_f32_dpp v244, v222, v236 row_newbcast:2 row_mask:0xf bank_mask:0xf
    v_mul_f32_dpp v245, v222, v237 row_newbcast:6 row_mask:0xf bank_mask:0xf
    v_mfma_f32_16x16x32_bf16 v[68:71], v[180:183], v[148:151], v[68:71]
    v_cvt_pk_bf16_f32 v172, v244, v245
    v_mul_f32_dpp v246, v222, v238 row_newbcast:10 row_mask:0xf bank_mask:0xf
    v_mfma_f32_16x16x32_bf16 v[68:71], v[168:171], v[156:159], v[68:71]
    v_mul_f32_dpp v247, v222, v239 row_newbcast:14 row_mask:0xf bank_mask:0xf
    v_cvt_pk_bf16_f32 v173, v246, v247
    s_sub_u32 s46, s46, 1
    s_cbranch_scc0 S0n10
    s_branch EP01
S0f00:
    v_mfma_f32_16x16x32_bf16 v[16:19], v[164:167], v[128:131], 0
    v_mul_f32_dpp v244, v222, v240 row_newbcast:1 row_mask:0xf bank_mask:0xf
    v_mul_f32_dpp v245, v222, v241 row_newbcast:5 row_mask:0xf bank_mask:0xf
    s_waitcnt vmcnt(7)
    ds_read_b64_tr_b16 v[144:145], v231 offset:4224
    ds_read_b64_tr_b16 v[148:149], v232 offset:4256
    ds_read_b64_tr_b16 v[152:153], v231 offset:4288
    ds_read_b64_tr_b16 v[156:157], v232 offset:4320
    v_mfma_f32_16x16x32_bf16 v[20:23], v[164:167], v[132:135], 0
    v_cvt_pk_bf16_f32 v174, v244, v245
    v_mul_f32_dpp v246, v222, v242 row_newbcast:9 row_mask:0xf bank_mask:0xf
    s_add_u32 m0, s51, 4224
    v_mfma_f32_16x16x32_bf16 v[8:11], v[164:167], v[136:139], 0
    v_mul_f32_dpp v247, v222, v243 row_newbcast:13 row_mask:0xf bank_mask:0xf
    v_cvt_pk_bf16_f32 v175, v246, v247
    s_waitcnt lgkmcnt(0)
    buffer_load_dwordx4 v226, s[4:7], s49 offen sc1 lds
    buffer_load_dwordx4 v227, s[4:7], s49 offen offset:1088 sc1 lds
    v_mfma_f32_16x16x32_bf16 v[12:15], v[164:167], v[140:143], 0
    v_mul_f32_dpp v244, v221, v236 row_newbcast:0 row_mask:0xf bank_mask:0xf
    v_mul_f32_dpp v245, v221, v237 row_newbcast:4 row_mask:0xf bank_mask:0xf
    v_cvt_pk_bf16_f32 v168, v244, v245
    v_mfma_f32_16x16x32_bf16 v[0:3], v[160:163], v[128:131], 0
    v_mul_f32_dpp v246, v221, v238 row_newbcast:8 row_mask:0xf bank_mask:0xf
    v_mul_f32_dpp v247, v221, v239 row_newbcast:12 row_mask:0xf bank_mask:0xf
    v_mfma_f32_16x16x32_bf16 v[4:7], v[160:163], v[132:135], 0
    v_cvt_pk_bf16_f32 v169, v246, v247
    v_mul_f32_dpp v244, v221, v240 row_newbcast:1 row_mask:0xf bank_mask:0xf
    v_mfma_f32_16x16x32_bf16 v[40:43], v[160:163], v[136:139], 0
    v_mul_f32_dpp v245, v221, v241 row_newbcast:5 row_mask:0xf bank_mask:0xf
    v_cvt_pk_bf16_f32 v170, v244, v245
    v_mfma_f32_16x16x32_bf16 v[44:47], v[160:163], v[140:143], 0
    v_mul_f32_dpp v246, v221, v242 row_newbcast:9 row_mask:0xf bank_mask:0xf
    v_mul_f32_dpp v247, v221, v243 row_newbcast:13 row_mask:0xf bank_mask:0xf
    v_mfma_f32_16x16x32_bf16 v[32:35], v[172:175], v[128:131], 0
    v_cvt_pk_bf16_f32 v171, v246, v247
    s_waitcnt vmcnt(7)
    ds_read_b64_tr_b16 v[146:147], v231 offset:0
    ds_read_b64_tr_b16 v[150:151], v232 offset:32
    ds_read_b64_tr_b16 v[154:155], v231 offset:64
    ds_read_b64_tr_b16 v[158:159], v232 offset:96
    v_mfma_f32_16x16x32_bf16 v[36:39], v[172:175], v[132:135], 0
    s_set_gpr_idx_on s45, gpr_idx(SRC1)
    v_mad_u32_u16 v235, 8, v199, 0
    v_lshlrev_b32 v220, 16, v198
    v_and_b32 v221, s100, v198
    v_and_b32 v222, s100, v199
    s_set_gpr_idx_off
    s_add_u32 m0, s51, 0
    v_mfma_f32_16x16x32_bf16 v[72:75], v[172:175], v[136:139], 0
    v_xor_b32 v176, s101, v164
    s_waitcnt lgkmcnt(0)
    buffer_load_dwordx4 v224, s[4:7], s50 offen sc1 lds
    buffer_load_dwordx4 v225, s[4:7], s50 offen offset:1088 sc1 lds
    v_mfma_f32_16x16x32_bf16 v[76:79], v[172:175], v[140:143], 0
    v_xor_b32 v177, s101, v165
    v_add_u32_dpp v248, v235, v230 quad_perm:[0,0,0,0] row_mask:0xf bank_mask:0xf
    v_add_u32_dpp v249, v235, v230 quad_perm:[1,1,1,1] row_mask:0xf bank_mask:0xf
    ds_read_b64_tr_b16 v[252:253], v248
    ds_read_b64_tr_b16 v[254:255], v249
    v_mfma_f32_16x16x32_bf16 v[24:27], v[168:171], v[128:131], 0
    v_xor_b32 v178, s101, v166
    v_xor_b32 v179, s101, v167
    v_mfma_f32_16x16x32_bf16 v[28:31], v[168:171], v[132:135], 0
    v_xor_b32 v180, s101, v172
    v_xor_b32 v181, s101, v173
    v_mfma_f32_16x16x32_bf16 v[80:83], v[168:171], v[136:139], 0
    v_xor_b32 v182, s101, v174
    v_xor_b32 v183, s101, v175
    v_mfma_f32_16x16x32_bf16 v[84:87], v[168:171], v[140:143], 0
    s_waitcnt lgkmcnt(0)
    v_lshlrev_b32 v236, 16, v252
    v_and_b32 v237, s100, v252
    v_mfma_f32_16x16x32_bf16 v[84:87], v[176:179], v[148:151], v[84:87]
    v_lshlrev_b32 v238, 16, v253
    v_and_b32 v239, s100, v253
    s_waitcnt vmcnt(7)
    ds_read_b64_tr_b16 v[128:129], v231 offset:2112
    ds_read_b64_tr_b16 v[132:133], v232 offset:2144
    ds_read_b64_tr_b16 v[136:137], v231 offset:2176
    ds_read_b64_tr_b16 v[140:141], v232 offset:2208
    v_mfma_f32_16x16x32_bf16 v[80:83], v[176:179], v[144:147], v[80:83]
    v_lshlrev_b32 v240, 16, v254
    v_and_b32 v241, s100, v254
    s_add_u32 m0, s51, 2112
    v_mfma_f32_16x16x32_bf16 v[72:75], v[176:179], v[152:155], v[72:75]
    v_lshlrev_b32 v242, 16, v255
    v_and_b32 v243, s100, v255
    s_waitcnt lgkmcnt(0)
    buffer_load_dwordx4 v226, s[4:7], s50 offen sc1 lds
    buffer_load_dwordx4 v227, s[4:7], s50 offen offset:1088 sc1 lds
    v_mfma_f32_16x16x32_bf16 v[76:79], v[176:179], v[156:159], v[76:79]
    v_mul_f32_dpp v244, v220, v236 row_newbcast:0 row_mask:0xf bank_mask:0xf
    v_mul_f32_dpp v245, v220, v237 row_newbcast:4 row_mask:0xf bank_mask:0xf
    v_cvt_pk_bf16_f32 v164, v244, v245
    v_mfma_f32_16x16x32_bf16 v[48:51], v[160:163], v[144:147], 0
    s_add_u32 s45, s45, 1
    s_cmp_lt_u32 s45, s44
    s_cbranch_scc0 S0f00_w
    s_lshr_b32 s54, s45, 1
    s_set_gpr_idx_on s54, gpr_idx(SRC0)
    v_mov_b32 v223, v188
    s_set_gpr_idx_off
    v_mul_f32_dpp v246, v220, v238 row_newbcast:8 row_mask:0xf bank_mask:0xf
    v_mov_b32_dpp v223, v223 row_shl:4 row_mask:0xf bank_mask:0x5
S0f00_b:
    v_mfma_f32_16x16x32_bf16 v[52:55], v[160:163], v[148:151], 0
    v_mul_f32_dpp v247, v220, v239 row_newbcast:12 row_mask:0xf bank_mask:0xf
    v_mfma_f32_16x16x32_bf16 v[56:59], v[160:163], v[152:155], 0
    v_cvt_pk_bf16_f32 v165, v246, v247
    v_add_u32_dpp v224, v223, v228 quad_perm:[0,0,0,0] row_mask:0xf bank_mask:0xf
    v_mfma_f32_16x16x32_bf16 v[60:63], v[160:163], v[156:159], 0
    v_add_u32_dpp v225, v223, v229 quad_perm:[1,1,1,1] row_mask:0xf bank_mask:0xf
    v_mul_f32_dpp v244, v220, v240 row_newbcast:1 row_mask:0xf bank_mask:0xf
    v_mfma_f32_16x16x32_bf16 v[8:11], v[168:171], v[144:147], v[8:11]
    v_mul_f32_dpp v245, v220, v241 row_newbcast:5 row_mask:0xf bank_mask:0xf
    v_cvt_pk_bf16_f32 v166, v244, v245
    s_waitcnt vmcnt(4)
    ds_read_b64_tr_b16 v[130:131], v231 offset:4224
    ds_read_b64_tr_b16 v[134:135], v232 offset:4256
    ds_read_b64_tr_b16 v[138:139], v231 offset:4288
    ds_read_b64_tr_b16 v[142:143], v232 offset:4320
    v_mfma_f32_16x16x32_bf16 v[8:11], v[172:175], v[152:155], v[8:11]
    v_mul_f32_dpp v246, v220, v242 row_newbcast:9 row_mask:0xf bank_mask:0xf
    v_mul_f32_dpp v247, v220, v243 row_newbcast:13 row_mask:0xf bank_mask:0xf
    s_add_u32 m0, s51, 4224
    v_mfma_f32_16x16x32_bf16 v[12:15], v[168:171], v[148:151], v[12:15]
    v_cvt_pk_bf16_f32 v167, v246, v247
    v_add_u32_dpp v226, v223, v228 quad_perm:[2,2,2,2] row_mask:0xf bank_mask:0xf
    s_waitcnt lgkmcnt(0)
    buffer_load_dwordx4 v224, s[4:7], s49 offen sc1 lds
    buffer_load_dwordx4 v225, s[4:7], s49 offen offset:1088 sc1 lds
    v_mfma_f32_16x16x32_bf16 v[12:15], v[172:175], v[156:159], v[12:15]
    v_add_u32_dpp v227, v223, v229 quad_perm:[3,3,3,3] row_mask:0xf bank_mask:0xf
    v_mfma_f32_16x16x32_bf16 v[64:67], v[180:183], v[144:147], 0
    v_mov_b32 v160, v252
    v_mov_b32 v161, v253
    v_mov_b32 v162, v254
    v_mov_b32 v163, v255
    v_mfma_f32_16x16x32_bf16 v[64:67], v[168:171], v[152:155], v[64:67]
    v_mul_f32_dpp v244, v222, v236 row_newbcast:0 row_mask:0xf bank_mask:0xf
    v_mul_f32_dpp v245, v222, v237 row_newbcast:4 row_mask:0xf bank_mask:0xf
    v_mfma_f32_16x16x32_bf16 v[68:71], v[180:183], v[148:151], 0
    v_cvt_pk_bf16_f32 v172, v244, v245
    v_mul_f32_dpp v246, v222, v238 row_newbcast:8 row_mask:0xf bank_mask:0xf
    v_mfma_f32_16x16x32_bf16 v[68:71], v[168:171], v[156:159], v[68:71]
    v_mul_f32_dpp v247, v222, v239 row_newbcast:12 row_mask:0xf bank_mask:0xf
    v_cvt_pk_bf16_f32 v173, v246, v247
    s_sub_u32 s46, s46, 1
    s_cbranch_scc0 S0f00_c
    s_branch EP10
S0n00:
    v_mfma_f32_16x16x32_bf16 v[16:19], v[164:167], v[128:131], v[16:19]
    v_mul_f32_dpp v244, v222, v240 row_newbcast:1 row_mask:0xf bank_mask:0xf
    v_mul_f32_dpp v245, v222, v241 row_newbcast:5 row_mask:0xf bank_mask:0xf
    s_waitcnt vmcnt(4)
    ds_read_b64_tr_b16 v[144:145], v231 offset:4224
    ds_read_b64_tr_b16 v[148:149], v232 offset:4256
    ds_read_b64_tr_b16 v[152:153], v231 offset:4288
    ds_read_b64_tr_b16 v[156:157], v232 offset:4320
    v_mfma_f32_16x16x32_bf16 v[20:23], v[164:167], v[132:135], v[20:23]
    v_cvt_pk_bf16_f32 v174, v244, v245
    v_mul_f32_dpp v246, v222, v242 row_newbcast:9 row_mask:0xf bank_mask:0xf
    s_add_u32 m0, s51, 4224
    v_mfma_f32_16x16x32_bf16 v[8:11], v[164:167], v[136:139], v[8:11]
    v_mul_f32_dpp v247, v222, v243 row_newbcast:13 row_mask:0xf bank_mask:0xf
    v_cvt_pk_bf16_f32 v175, v246, v247
    s_waitcnt lgkmcnt(0)
    buffer_load_dwordx4 v226, s[4:7], s49 offen sc1 lds
    buffer_load_dwordx4 v227, s[4:7], s49 offen offset:1088 sc1 lds
    v_mfma_f32_16x16x32_bf16 v[12:15], v[164:167], v[140:143], v[12:15]
    v_mul_f32_dpp v244, v221, v236 row_newbcast:0 row_mask:0xf bank_mask:0xf
    v_mul_f32_dpp v245, v221, v237 row_newbcast:4 row_mask:0xf bank_mask:0xf
    v_cvt_pk_bf16_f32 v168, v244, v245
    v_mfma_f32_16x16x32_bf16 v[0:3], v[160:163], v[128:131], v[0:3]
    v_mul_f32_dpp v246, v221, v238 row_newbcast:8 row_mask:0xf bank_mask:0xf
    v_mul_f32_dpp v247, v221, v239 row_newbcast:12 row_mask:0xf bank_mask:0xf
    v_mfma_f32_16x16x32_bf16 v[4:7], v[160:163], v[132:135], v[4:7]
    v_cvt_pk_bf16_f32 v169, v246, v247
    v_mul_f32_dpp v244, v221, v240 row_newbcast:1 row_mask:0xf bank_mask:0xf
    v_mfma_f32_16x16x32_bf16 v[40:43], v[160:163], v[136:139], v[40:43]
    v_mul_f32_dpp v245, v221, v241 row_newbcast:5 row_mask:0xf bank_mask:0xf
    v_cvt_pk_bf16_f32 v170, v244, v245
    v_mfma_f32_16x16x32_bf16 v[44:47], v[160:163], v[140:143], v[44:47]
    v_mul_f32_dpp v246, v221, v242 row_newbcast:9 row_mask:0xf bank_mask:0xf
    v_mul_f32_dpp v247, v221, v243 row_newbcast:13 row_mask:0xf bank_mask:0xf
    v_mfma_f32_16x16x32_bf16 v[32:35], v[172:175], v[128:131], v[32:35]
    v_cvt_pk_bf16_f32 v171, v246, v247
    s_waitcnt vmcnt(4)
    ds_read_b64_tr_b16 v[146:147], v231 offset:0
    ds_read_b64_tr_b16 v[150:151], v232 offset:32
    ds_read_b64_tr_b16 v[154:155], v231 offset:64
    ds_read_b64_tr_b16 v[158:159], v232 offset:96
    v_mfma_f32_16x16x32_bf16 v[36:39], v[172:175], v[132:135], v[36:39]
    s_set_gpr_idx_on s45, gpr_idx(SRC1)
    v_mad_u32_u16 v235, 8, v199, 0
    v_lshlrev_b32 v220, 16, v198
    v_and_b32 v221, s100, v198
    v_and_b32 v222, s100, v199
    s_set_gpr_idx_off
    s_add_u32 m0, s51, 0
    v_mfma_f32_16x16x32_bf16 v[72:75], v[172:175], v[136:139], v[72:75]
    v_xor_b32 v176, s101, v164
    s_waitcnt lgkmcnt(0)
    buffer_load_dwordx4 v224, s[4:7], s50 offen sc1 lds
    buffer_load_dwordx4 v225, s[4:7], s50 offen offset:1088 sc1 lds
    v_mfma_f32_16x16x32_bf16 v[76:79], v[172:175], v[140:143], v[76:79]
    v_xor_b32 v177, s101, v165
    v_add_u32_dpp v248, v235, v230 quad_perm:[0,0,0,0] row_mask:0xf bank_mask:0xf
    v_add_u32_dpp v249, v235, v230 quad_perm:[1,1,1,1] row_mask:0xf bank_mask:0xf
    ds_read_b64_tr_b16 v[252:253], v248
    ds_read_b64_tr_b16 v[254:255], v249
    v_mfma_f32_16x16x32_bf16 v[24:27], v[168:171], v[128:131], v[24:27]
    v_xor_b32 v178, s101, v166
    v_xor_b32 v179, s101, v167
    v_mfma_f32_16x16x32_bf16 v[28:31], v[168:171], v[132:135], v[28:31]
    v_xor_b32 v180, s101, v172
    v_xor_b32 v181, s101, v173
    v_mfma_f32_16x16x32_bf16 v[80:83], v[168:171], v[136:139], v[80:83]
    v_xor_b32 v182, s101, v174
    v_xor_b32 v183, s101, v175
    v_mfma_f32_16x16x32_bf16 v[84:87], v[168:171], v[140:143], v[84:87]
    s_waitcnt lgkmcnt(0)
    v_lshlrev_b32 v236, 16, v252
    v_and_b32 v237, s100, v252
    v_mfma_f32_16x16x32_bf16 v[84:87], v[176:179], v[148:151], v[84:87]
    v_lshlrev_b32 v238, 16, v253
    v_and_b32 v239, s100, v253
    s_waitcnt vmcnt(4)
    ds_read_b64_tr_b16 v[128:129], v231 offset:2112
    ds_read_b64_tr_b16 v[132:133], v232 offset:2144
    ds_read_b64_tr_b16 v[136:137], v231 offset:2176
    ds_read_b64_tr_b16 v[140:141], v232 offset:2208
    v_mfma_f32_16x16x32_bf16 v[80:83], v[176:179], v[144:147], v[80:83]
    v_lshlrev_b32 v240, 16, v254
    v_and_b32 v241, s100, v254
    s_add_u32 m0, s51, 2112
    v_mfma_f32_16x16x32_bf16 v[72:75], v[176:179], v[152:155], v[72:75]
    v_lshlrev_b32 v242, 16, v255
    v_and_b32 v243, s100, v255
    s_waitcnt lgkmcnt(0)
    buffer_load_dwordx4 v226, s[4:7], s50 offen sc1 lds
    buffer_load_dwordx4 v227, s[4:7], s50 offen offset:1088 sc1 lds
    v_mfma_f32_16x16x32_bf16 v[76:79], v[176:179], v[156:159], v[76:79]
    v_mul_f32_dpp v244, v220, v236 row_newbcast:0 row_mask:0xf bank_mask:0xf
    v_mul_f32_dpp v245, v220, v237 row_newbcast:4 row_mask:0xf bank_mask:0xf
    v_cvt_pk_bf16_f32 v164, v244, v245
    v_mfma_f32_16x16x32_bf16 v[48:51], v[160:163], v[144:147], v[48:51]
    s_add_u32 s45, s45, 1
    s_cmp_lt_u32 s45, s44
    s_cbranch_scc0 S0n00_w
    s_lshr_b32 s54, s45, 1
    s_set_gpr_idx_on s54, gpr_idx(SRC0)
    v_mov_b32 v223, v188
    s_set_gpr_idx_off
    v_mul_f32_dpp v246, v220, v238 row_newbcast:8 row_mask:0xf bank_mask:0xf
    v_mov_b32_dpp v223, v223 row_shl:4 row_mask:0xf bank_mask:0x5
S0n00_b:
    v_mfma_f32_16x16x32_bf16 v[52:55], v[160:163], v[148:151], v[52:55]
    v_mul_f32_dpp v247, v220, v239 row_newbcast:12 row_mask:0xf bank_mask:0xf
    v_mfma_f32_16x16x32_bf16 v[56:59], v[160:163], v[152:155], v[56:59]
    v_cvt_pk_bf16_f32 v165, v246, v247
    v_add_u32_dpp v224, v223, v228 quad_perm:[0,0,0,0] row_mask:0xf bank_mask:0xf
    v_mfma_f32_16x16x32_bf16 v[60:63], v[160:163], v[156:159], v[60:63]
    v_add_u32_dpp v225, v223, v229 quad_perm:[1,1,1,1] row_mask:0xf bank_mask:0xf
    v_mul_f32_dpp v244, v220, v240 row_newbcast:1 row_mask:0xf bank_mask:0xf
    v_mfma_f32_16x16x32_bf16 v[8:11], v[168:171], v[144:147], v[8:11]
    v_mul_f32_dpp v245, v220, v241 row_newbcast:5 row_mask:0xf bank_mask:0xf
    v_cvt_pk_bf16_f32 v166, v244, v245
    s_waitcnt vmcnt(4)
    ds_read_b64_tr_b16 v[130:131], v231 offset:4224
    ds_read_b64_tr_b16 v[134:135], v232 offset:4256
    ds_read_b64_tr_b16 v[138:139], v231 offset:4288
    ds_read_b64_tr_b16 v[142:143], v232 offset:4320
    v_mfma_f32_16x16x32_bf16 v[8:11], v[172:175], v[152:155], v[8:11]
    v_mul_f32_dpp v246, v220, v242 row_newbcast:9 row_mask:0xf bank_mask:0xf
    v_mul_f32_dpp v247, v220, v243 row_newbcast:13 row_mask:0xf bank_mask:0xf
    s_add_u32 m0, s51, 4224
    v_mfma_f32_16x16x32_bf16 v[12:15], v[168:171], v[148:151], v[12:15]
    v_cvt_pk_bf16_f32 v167, v246, v247
    v_add_u32_dpp v226, v223, v228 quad_perm:[2,2,2,2] row_mask:0xf bank_mask:0xf
    s_waitcnt lgkmcnt(0)
    buffer_load_dwordx4 v224, s[4:7], s49 offen sc1 lds
    buffer_load_dwordx4 v225, s[4:7], s49 offen offset:1088 sc1 lds
    v_mfma_f32_16x16x32_bf16 v[12:15], v[172:175], v[156:159], v[12:15]
    v_add_u32_dpp v227, v223, v229 quad_perm:[3,3,3,3] row_mask:0xf bank_mask:0xf
    v_mfma_f32_16x16x32_bf16 v[64:67], v[180:183], v[144:147], v[64:67]
    v_mov_b32 v160, v252
    v_mov_b32 v161, v253
    v_mov_b32 v162, v254
    v_mov_b32 v163, v255
    v_mfma_f32_16x16x32_bf16 v[64:67], v[168:171], v[152:155], v[64:67]
    v_mul_f32_dpp v244, v222, v236 row_newbcast:0 row_mask:0xf bank_mask:0xf
    v_mul_f32_dpp v245, v222, v237 row_newbcast:4 row_mask:0xf bank_mask:0xf
    v_mfma_f32_16x16x32_bf16 v[68:71], v[180:183], v[148:151], v[68:71]
    v_cvt_pk_bf16_f32 v172, v244, v245
    v_mul_f32_dpp v246, v222, v238 row_newbcast:8 row_mask:0xf bank_mask:0xf
    v_mfma_f32_16x16x32_bf16 v[68:71], v[168:171], v[156:159], v[68:71]
    v_mul_f32_dpp v247, v222, v239 row_newbcast:12 row_mask:0xf bank_mask:0xf
    v_cvt_pk_bf16_f32 v173, v246, v247
    s_sub_u32 s46, s46, 1
    s_cbranch_scc0 S0n00_c
    s_branch EP10
S1f00:
    v_mfma_f32_16x16x32_bf16 v[16:19], v[164:167], v[128:131], 0
    v_mul_f32_dpp v244, v222, v240 row_newbcast:1 row_mask:0xf bank_mask:0xf
    v_mul_f32_dpp v245, v222, v241 row_newbcast:5 row_mask:0xf bank_mask:0xf
    s_waitcnt vmcnt(7)
    ds_read_b64_tr_b16 v[144:145], v231 offset:0
    ds_read_b64_tr_b16 v[148:149], v232 offset:32
    ds_read_b64_tr_b16 v[152:153], v231 offset:64
    ds_read_b64_tr_b16 v[156:157], v232 offset:96
    v_mfma_f32_16x16x32_bf16 v[20:23], v[164:167], v[132:135], 0
    v_cvt_pk_bf16_f32 v174, v244, v245
    v_mul_f32_dpp v246, v222, v242 row_newbcast:9 row_mask:0xf bank_mask:0xf
    s_add_u32 m0, s51, 0
    v_mfma_f32_16x16x32_bf16 v[8:11], v[164:167], v[136:139], 0
    v_mul_f32_dpp v247, v222, v243 row_newbcast:13 row_mask:0xf bank_mask:0xf
    v_cvt_pk_bf16_f32 v175, v246, v247
    s_waitcnt lgkmcnt(0)
    buffer_load_dwordx4 v226, s[4:7], s49 offen sc1 lds
    buffer_load_dwordx4 v227, s[4:7], s49 offen offset:1088 sc1 lds
    v_mfma_f32_16x16x32_bf16 v[12:15], v[164:167], v[140:143], 0
    v_mul_f32_dpp v244, v221, v236 row_newbcast:0 row_mask:0xf bank_mask:0xf
    v_mul_f32_dpp v245, v221, v237 row_newbcast:4 row_mask:0xf bank_mask:0xf
    v_cvt_pk_bf16_f32 v168, v244, v245
    v_mfma_f32_16x16x32_bf16 v[0:3], v[160:163], v[128:131], 0
    v_mul_f32_dpp v246, v221, v238 row_newbcast:8 row_mask:0xf bank_mask:0xf
    v_mul_f32_dpp v247, v221, v239 row_newbcast:12 row_mask:0xf bank_mask:0xf
    v_mfma_f32_16x16x32_bf16 v[4:7], v[160:163], v[132:135], 0
    v_cvt_pk_bf16_f32 v169, v246, v247
    v_mul_f32_dpp v244, v221, v240 row_newbcast:1 row_mask:0xf bank_mask:0xf
    v_mfma_f32_16x16x32_bf16 v[40:43], v[160:163], v[136:139], 0
    v_mul_f32_dpp v245, v221, v241 row_newbcast:5 row_mask:0xf bank_mask:0xf
    v_cvt_pk_bf16_f32 v170, v244, v245
    v_mfma_f32_16x16x32_bf16 v[44:47], v[160:163], v[140:143], 0
    v_mul_f32_dpp v246, v221, v242 row_newbcast:9 row_mask:0xf bank_mask:0xf
    v_mul_f32_dpp v247, v221, v243 row_newbcast:13 row_mask:0xf bank_mask:0xf
    v_mfma_f32_16x16x32_bf16 v[32:35], v[172:175], v[128:131], 0
    v_cvt_pk_bf16_f32 v171, v246, v247
    s_waitcnt vmcnt(7)
    ds_read_b64_tr_b16 v[146:147], v231 offset:2112
    ds_read_b64_tr_b16 v[150:151], v232 offset:2144
    ds_read_b64_tr_b16 v[154:155], v231 offset:2176
    ds_read_b64_tr_b16 v[158:159], v232 offset:2208
    v_mfma_f32_16x16x32_bf16 v[36:39], v[172:175], v[132:135], 0
    s_set_gpr_idx_on s45, gpr_idx(SRC1)
    v_mad_u32_u16 v235, 8, v199, 0
    v_lshlrev_b32 v220, 16, v198
    v_and_b32 v221, s100, v198
    v_and_b32 v222, s100, v199
    s_set_gpr_idx_off
    s_add_u32 m0, s51, 2112
    v_mfma_f32_16x16x32_bf16 v[72:75], v[172:175], v[136:139], 0
    v_xor_b32 v176, s101, v164
    s_waitcnt lgkmcnt(0)
    buffer_load_dwordx4 v224, s[4:7], s50 offen sc1 lds
    buffer_load_dwordx4 v225, s[4:7], s50 offen offset:1088 sc1 lds
    v_mfma_f32_16x16x32_bf16 v[76:79], v[172:175], v[140:143], 0
    v_xor_b32 v177, s101, v165
    v_add_u32_dpp v248, v235, v230 quad_perm:[0,0,0,0] row_mask:0xf bank_mask:0xf
    v_add_u32_dpp v249, v235, v230 quad_perm:[1,1,1,1] row_mask:0xf bank_mask:0xf
    ds_read_b64_tr_b16 v[252:253], v248
    ds_read_b64_tr_b16 v[254:255], v249
    v_mfma_f32_16x16x32_bf16 v[24:27], v[168:171], v[128:131], 0
    v_xor_b32 v178, s101, v166
    v_xor_b32 v179, s101, v167
    v_mfma_f32_16x16x32_bf16 v[28:31], v[168:171], v[132:135], 0
    v_xor_b32 v180, s101, v172
    v_xor_b32 v181, s101, v173
    v_mfma_f32_16x16x32_bf16 v[80:83], v[168:171], v[136:139], 0
    v_xor_b32 v182, s101, v174
    v_xor_b32 v183, s101, v175
    v_mfma_f32_16x16x32_bf16 v[84:87], v[168:171], v[140:143], 0
    s_waitcnt lgkmcnt(0)
    v_lshlrev_b32 v236, 16, v252
    v_and_b32 v237, s100, v252
    v_mfma_f32_16x16x32_bf16 v[84:87], v[176:179], v[148:151], v[84:87]
    v_lshlrev_b32 v238, 16, v253
    v_and_b32 v239, s100, v253
    s_waitcnt vmcnt(7)
    ds_read_b64_tr_b16 v[128:129], v231 offset:4224
    ds_read_b64_tr_b16 v[132:133], v232 offset:4256
    ds_read_b64_tr_b16 v[136:137], v231 offset:4288
    ds_read_b64_tr_b16 v[140:141], v232 offset:4320
    v_mfma_f32_16x16x32_bf16 v[80:83], v[176:179], v[144:147], v[80:83]
    v_lshlrev_b32 v240, 16, v254
    v_and_b32 v241, s100, v254
    s_add_u32 m0, s51, 4224
    v_mfma_f32_16x16x32_bf16 v[72:75], v[176:179], v[152:155], v[72:75]
    v_lshlrev_b32 v242, 16, v255
    v_and_b32 v243, s100, v255
    s_waitcnt lgkmcnt(0)
    buffer_load_dwordx4 v226, s[4:7], s50 offen sc1 lds
    buffer_load_dwordx4 v227, s[4:7], s50 offen offset:1088 sc1 lds
    v_mfma_f32_16x16x32_bf16 v[76:79], v[176:179], v[156:159], v[76:79]
    v_mul_f32_dpp v244, v220, v236 row_newbcast:0 row_mask:0xf bank_mask:0xf
    v_mul_f32_dpp v245, v220, v237 row_newbcast:4 row_mask:0xf bank_mask:0xf
    v_cvt_pk_bf16_f32 v164, v244, v245
    v_mfma_f32_16x16x32_bf16 v[48:51], v[160:163], v[144:147], 0
    s_add_u32 s45, s45, 1
    s_cmp_lt_u32 s45, s44
    s_cbranch_scc0 S1f00_w
    s_lshr_b32 s54, s45, 1
    s_set_gpr_idx_on s54, gpr_idx(SRC0)
    v_mov_b32 v223, v188
    s_set_gpr_idx_off
    v_mul_f32_dpp v246, v220, v238 row_newbcast:8 row_mask:0xf bank_mask:0xf
    v_mov_b32_dpp v223, v223 row_shl:4 row_mask:0xf bank_mask:0x5
S1f00_b:
    v_mfma_f32_16x16x32_bf16 v[52:55], v[160:163], v[148:151], 0
    v_mul_f32_dpp v247, v220, v239 row_newbcast:12 row_mask:0xf bank_mask:0xf
    v_mfma_f32_16x16x32_bf16 v[56:59], v[160:163], v[152:155], 0
    v_cvt_pk_bf16_f32 v165, v246, v247
    v_add_u32_dpp v224, v223, v228 quad_perm:[0,0,0,0] row_mask:0xf bank_mask:0xf
    v_mfma_f32_16x16x32_bf16 v[60:63], v[160:163], v[156:159], 0
    v_add_u32_dpp v225, v223, v229 quad_perm:[1,1,1,1] row_mask:0xf bank_mask:0xf
    v_mul_f32_dpp v244, v220, v240 row_newbcast:1 row_mask:0xf bank_mask:0xf
    v_mfma_f32_16x16x32_bf16 v[8:11], v[168:171], v[144:147], v[8:11]
    v_mul_f32_dpp v245, v220, v241 row_newbcast:5 row_mask:0xf bank_mask:0xf
    v_cvt_pk_bf16_f32 v166, v244, v245
    s_waitcnt vmcnt(4)
    ds_read_b64_tr_b16 v[130:131], v231 offset:0
    ds_read_b64_tr_b16 v[134:135], v232 offset:32
    ds_read_b64_tr_b16 v[138:139], v231 offset:64
    ds_read_b64_tr_b16 v[142:143], v232 offset:96
    v_mfma_f32_16x16x32_bf16 v[8:11], v[172:175], v[152:155], v[8:11]
    v_mul_f32_dpp v246, v220, v242 row_newbcast:9 row_mask:0xf bank_mask:0xf
    v_mul_f32_dpp v247, v220, v243 row_newbcast:13 row_mask:0xf bank_mask:0xf
    s_add_u32 m0, s51, 0
    v_mfma_f32_16x16x32_bf16 v[12:15], v[168:171], v[148:151], v[12:15]
    v_cvt_pk_bf16_f32 v167, v246, v247
    v_add_u32_dpp v226, v223, v228 quad_perm:[2,2,2,2] row_mask:0xf bank_mask:0xf
    s_waitcnt lgkmcnt(0)
    buffer_load_dwordx4 v224, s[4:7], s49 offen sc1 lds
    buffer_load_dwordx4 v225, s[4:7], s49 offen offset:1088 sc1 lds
    v_mfma_f32_16x16x32_bf16 v[12:15], v[172:175], v[156:159], v[12:15]
    v_add_u32_dpp v227, v223, v229 quad_perm:[3,3,3,3] row_mask:0xf bank_mask:0xf
    v_mfma_f32_16x16x32_bf16 v[64:67], v[180:183], v[144:147], 0
    v_mov_b32 v160, v252
    v_mov_b32 v161, v253
    v_mov_b32 v162, v254
    v_mov_b32 v163, v255
    v_mfma_f32_16x16x32_bf16 v[64:67], v[168:171], v[152:155], v[64:67]
    v_mul_f32_dpp v244, v222, v236 row_newbcast:0 row_mask:0xf bank_mask:0xf
    v_mul_f32_dpp v245, v222, v237 row_newbcast:4 row_mask:0xf bank_mask:0xf
    v_mfma_f32_16x16x32_bf16 v[68:71], v[180:183], v[148:151], 0
    v_cvt_pk_bf16_f32 v172, v244, v245
    v_mul_f32_dpp v246, v222, v238 row_newbcast:8 row_mask:0xf bank_mask:0xf
    v_mfma_f32_16x16x32_bf16 v[68:71], v[168:171], v[156:159], v[68:71]
    v_mul_f32_dpp v247, v222, v239 row_newbcast:12 row_mask:0xf bank_mask:0xf
    v_cvt_pk_bf16_f32 v173, v246, v247
    s_sub_u32 s46, s46, 1
    s_cbranch_scc0 S1f00_c
    s_branch EP20
S1n00:
    v_mfma_f32_16x16x32_bf16 v[16:19], v[164:167], v[128:131], v[16:19]
    v_mul_f32_dpp v244, v222, v240 row_newbcast:1 row_mask:0xf bank_mask:0xf
    v_mul_f32_dpp v245, v222, v241 row_newbcast:5 row_mask:0xf bank_mask:0xf
    s_waitcnt vmcnt(4)
    ds_read_b64_tr_b16 v[144:145], v231 offset:0
    ds_read_b64_tr_b16 v[148:149], v232 offset:32
    ds_read_b64_tr_b16 v[152:153], v231 offset:64
    ds_read_b64_tr_b16 v[156:157], v232 offset:96
    v_mfma_f32_16x16x32_bf16 v[20:23], v[164:167], v[132:135], v[20:23]
    v_cvt_pk_bf16_f32 v174, v244, v245
    v_mul_f32_dpp v246, v222, v242 row_newbcast:9 row_mask:0xf bank_mask:0xf
    s_add_u32 m0, s51, 0
    v_mfma_f32_16x16x32_bf16 v[8:11], v[164:167], v[136:139], v[8:11]
    v_mul_f32_dpp v247, v222, v243 row_newbcast:13 row_mask:0xf bank_mask:0xf
    v_cvt_pk_bf16_f32 v175, v246, v247
    s_waitcnt lgkmcnt(0)
    buffer_load_dwordx4 v226, s[4:7], s49 offen sc1 lds
    buffer_load_dwordx4 v227, s[4:7], s49 offen offset:1088 sc1 lds
    v_mfma_f32_16x16x32_bf16 v[12:15], v[164:167], v[140:143], v[12:15]
    v_mul_f32_dpp v244, v221, v236 row_newbcast:0 row_mask:0xf bank_mask:0xf
    v_mul_f32_dpp v245, v221, v237 row_newbcast:4 row_mask:0xf bank_mask:0xf
    v_cvt_pk_bf16_f32 v168, v244, v245
    v_mfma_f32_16x16x32_bf16 v[0:3], v[160:163], v[128:131], v[0:3]
    v_mul_f32_dpp v246, v221, v238 row_newbcast:8 row_mask:0xf bank_mask:0xf
    v_mul_f32_dpp v247, v221, v239 row_newbcast:12 row_mask:0xf bank_mask:0xf
    v_mfma_f32_16x16x32_bf16 v[4:7], v[160:163], v[132:135], v[4:7]
    v_cvt_pk_bf16_f32 v169, v246, v247
    v_mul_f32_dpp v244, v221, v240 row_newbcast:1 row_mask:0xf bank_mask:0xf
    v_mfma_f32_16x16x32_bf16 v[40:43], v[160:163], v[136:139], v[40:43]
    v_mul_f32_dpp v245, v221, v241 row_newbcast:5 row_mask:0xf bank_mask:0xf
    v_cvt_pk_bf16_f32 v170, v244, v245
    v_mfma_f32_16x16x32_bf16 v[44:47], v[160:163], v[140:143], v[44:47]
    v_mul_f32_dpp v246, v221, v242 row_newbcast:9 row_mask:0xf bank_mask:0xf
    v_mul_f32_dpp v247, v221, v243 row_newbcast:13 row_mask:0xf bank_mask:0xf
    v_mfma_f32_16x16x32_bf16 v[32:35], v[172:175], v[128:131], v[32:35]
    v_cvt_pk_bf16_f32 v171, v246, v247
    s_waitcnt vmcnt(4)
    ds_read_b64_tr_b16 v[146:147], v231 offset:2112
    ds_read_b64_tr_b16 v[150:151], v232 offset:2144
    ds_read_b64_tr_b16 v[154:155], v231 offset:2176
    ds_read_b64_tr_b16 v[158:159], v232 offset:2208
    v_mfma_f32_16x16x32_bf16 v[36:39], v[172:175], v[132:135], v[36:39]
    s_set_gpr_idx_on s45, gpr_idx(SRC1)
    v_mad_u32_u16 v235, 8, v199, 0
    v_lshlrev_b32 v220, 16, v198
    v_and_b32 v221, s100, v198
    v_and_b32 v222, s100, v199
    s_set_gpr_idx_off
    s_add_u32 m0, s51, 2112
    v_mfma_f32_16x16x32_bf16 v[72:75], v[172:175], v[136:139], v[72:75]
    v_xor_b32 v176, s101, v164
    s_waitcnt lgkmcnt(0)
    buffer_load_dwordx4 v224, s[4:7], s50 offen sc1 lds
    buffer_load_dwordx4 v225, s[4:7], s50 offen offset:1088 sc1 lds
    v_mfma_f32_16x16x32_bf16 v[76:79], v[172:175], v[140:143], v[76:79]
    v_xor_b32 v177, s101, v165
    v_add_u32_dpp v248, v235, v230 quad_perm:[0,0,0,0] row_mask:0xf bank_mask:0xf
    v_add_u32_dpp v249, v235, v230 quad_perm:[1,1,1,1] row_mask:0xf bank_mask:0xf
    ds_read_b64_tr_b16 v[252:253], v248
    ds_read_b64_tr_b16 v[254:255], v249
    v_mfma_f32_16x16x32_bf16 v[24:27], v[168:171], v[128:131], v[24:27]
    v_xor_b32 v178, s101, v166
    v_xor_b32 v179, s101, v167
    v_mfma_f32_16x16x32_bf16 v[28:31], v[168:171], v[132:135], v[28:31]
    v_xor_b32 v180, s101, v172
    v_xor_b32 v181, s101, v173
    v_mfma_f32_16x16x32_bf16 v[80:83], v[168:171], v[136:139], v[80:83]
    v_xor_b32 v182, s101, v174
    v_xor_b32 v183, s101, v175
    v_mfma_f32_16x16x32_bf16 v[84:87], v[168:171], v[140:143], v[84:87]
    s_waitcnt lgkmcnt(0)
    v_lshlrev_b32 v236, 16, v252
    v_and_b32 v237, s100, v252
    v_mfma_f32_16x16x32_bf16 v[84:87], v[176:179], v[148:151], v[84:87]
    v_lshlrev_b32 v238, 16, v253
    v_and_b32 v239, s100, v253
    s_waitcnt vmcnt(4)
    ds_read_b64_tr_b16 v[128:129], v231 offset:4224
    ds_read_b64_tr_b16 v[132:133], v232 offset:4256
    ds_read_b64_tr_b16 v[136:137], v231 offset:4288
    ds_read_b64_tr_b16 v[140:141], v232 offset:4320
    v_mfma_f32_16x16x32_bf16 v[80:83], v[176:179], v[144:147], v[80:83]
    v_lshlrev_b32 v240, 16, v254
    v_and_b32 v241, s100, v254
    s_add_u32 m0, s51, 4224
    v_mfma_f32_16x16x32_bf16 v[72:75], v[176:179], v[152:155], v[72:75]
    v_lshlrev_b32 v242, 16, v255
    v_and_b32 v243, s100, v255
    s_waitcnt lgkmcnt(0)
    buffer_load_dwordx4 v226, s[4:7], s50 offen sc1 lds
    buffer_load_dwordx4 v227, s[4:7], s50 offen offset:1088 sc1 lds
    v_mfma_f32_16x16x32_bf16 v[76:79], v[176:179], v[156:159], v[76:79]
    v_mul_f32_dpp v244, v220, v236 row_newbcast:0 row_mask:0xf bank_mask:0xf
    v_mul_f32_dpp v245, v220, v237 row_newbcast:4 row_mask:0xf bank_mask:0xf
    v_cvt_pk_bf16_f32 v164, v244, v245
    v_mfma_f32_16x16x32_bf16 v[48:51], v[160:163], v[144:147], v[48:51]
    s_add_u32 s45, s45, 1
    s_cmp_lt_u32 s45, s44
    s_cbranch_scc0 S1n00_w
    s_lshr_b32 s54, s45, 1
    s_set_gpr_idx_on s54, gpr_idx(SRC0)
    v_mov_b32 v223, v188
    s_set_gpr_idx_off
    v_mul_f32_dpp v246, v220, v238 row_newbcast:8 row_mask:0xf bank_mask:0xf
    v_mov_b32_dpp v223, v223 row_shl:4 row_mask:0xf bank_mask:0x5
S1n00_b:
    v_mfma_f32_16x16x32_bf16 v[52:55], v[160:163], v[148:151], v[52:55]
    v_mul_f32_dpp v247, v220, v239 row_newbcast:12 row_mask:0xf bank_mask:0xf
    v_mfma_f32_16x16x32_bf16 v[56:59], v[160:163], v[152:155], v[56:59]
    v_cvt_pk_bf16_f32 v165, v246, v247
    v_add_u32_dpp v224, v223, v228 quad_perm:[0,0,0,0] row_mask:0xf bank_mask:0xf
    v_mfma_f32_16x16x32_bf16 v[60:63], v[160:163], v[156:159], v[60:63]
    v_add_u32_dpp v225, v223, v229 quad_perm:[1,1,1,1] row_mask:0xf bank_mask:0xf
    v_mul_f32_dpp v244, v220, v240 row_newbcast:1 row_mask:0xf bank_mask:0xf
    v_mfma_f32_16x16x32_bf16 v[8:11], v[168:171], v[144:147], v[8:11]
    v_mul_f32_dpp v245, v220, v241 row_newbcast:5 row_mask:0xf bank_mask:0xf
    v_cvt_pk_bf16_f32 v166, v244, v245
    s_waitcnt vmcnt(4)
    ds_read_b64_tr_b16 v[130:131], v231 offset:0
    ds_read_b64_tr_b16 v[134:135], v232 offset:32
    ds_read_b64_tr_b16 v[138:139], v231 offset:64
    ds_read_b64_tr_b16 v[142:143], v232 offset:96
    v_mfma_f32_16x16x32_bf16 v[8:11], v[172:175], v[152:155], v[8:11]
    v_mul_f32_dpp v246, v220, v242 row_newbcast:9 row_mask:0xf bank_mask:0xf
    v_mul_f32_dpp v247, v220, v243 row_newbcast:13 row_mask:0xf bank_mask:0xf
    s_add_u32 m0, s51, 0
    v_mfma_f32_16x16x32_bf16 v[12:15], v[168:171], v[148:151], v[12:15]
    v_cvt_pk_bf16_f32 v167, v246, v247
    v_add_u32_dpp v226, v223, v228 quad_perm:[2,2,2,2] row_mask:0xf bank_mask:0xf
    s_waitcnt lgkmcnt(0)
    buffer_load_dwordx4 v224, s[4:7], s49 offen sc1 lds
    buffer_load_dwordx4 v225, s[4:7], s49 offen offset:1088 sc1 lds
    v_mfma_f32_16x16x32_bf16 v[12:15], v[172:175], v[156:159], v[12:15]
    v_add_u32_dpp v227, v223, v229 quad_perm:[3,3,3,3] row_mask:0xf bank_mask:0xf
    v_mfma_f32_16x16x32_bf16 v[64:67], v[180:183], v[144:147], v[64:67]
    v_mov_b32 v160, v252
    v_mov_b32 v161, v253
    v_mov_b32 v162, v254
    v_mov_b32 v163, v255
    v_mfma_f32_16x16x32_bf16 v[64:67], v[168:171], v[152:155], v[64:67]
    v_mul_f32_dpp v244, v222, v236 row_newbcast:0 row_mask:0xf bank_mask:0xf
    v_mul_f32_dpp v245, v222, v237 row_newbcast:4 row_mask:0xf bank_mask:0xf
    v_mfma_f32_16x16x32_bf16 v[68:71], v[180:183], v[148:151], v[68:71]
    v_cvt_pk_bf16_f32 v172, v244, v245
    v_mul_f32_dpp v246, v222, v238 row_newbcast:8 row_mask:0xf bank_mask:0xf
    v_mfma_f32_16x16x32_bf16 v[68:71], v[168:171], v[156:159], v[68:71]
    v_mul_f32_dpp v247, v222, v239 row_newbcast:12 row_mask:0xf bank_mask:0xf
    v_cvt_pk_bf16_f32 v173, v246, v247
    s_sub_u32 s46, s46, 1
    s_cbranch_scc0 S1n00_c
    s_branch EP20
S2f00:
    v_mfma_f32_16x16x32_bf16 v[16:19], v[164:167], v[128:131], 0
    v_mul_f32_dpp v244, v222, v240 row_newbcast:1 row_mask:0xf bank_mask:0xf
    v_mul_f32_dpp v245, v222, v241 row_newbcast:5 row_mask:0xf bank_mask:0xf
    s_waitcnt vmcnt(7)
    ds_read_b64_tr_b16 v[144:145], v231 offset:2112
    ds_read_b64_tr_b16 v[148:149], v232 offset:2144
    ds_read_b64_tr_b16 v[152:153], v231 offset:2176
    ds_read_b64_tr_b16 v[156:157], v232 offset:2208
    v_mfma_f32_16x16x32_bf16 v[20:23], v[164:167], v[132:135], 0
    v_cvt_pk_bf16_f32 v174, v244, v245
    v_mul_f32_dpp v246, v222, v242 row_newbcast:9 row_mask:0xf bank_mask:0xf
    s_add_u32 m0, s51, 2112
    v_mfma_f32_16x16x32_bf16 v[8:11], v[164:167], v[136:139], 0
    v_mul_f32_dpp v247, v222, v243 row_newbcast:13 row_mask:0xf bank_mask:0xf
    v_cvt_pk_bf16_f32 v175, v246, v247
    s_waitcnt lgkmcnt(0)
    buffer_load_dwordx4 v226, s[4:7], s49 offen sc1 lds
    buffer_load_dwordx4 v227, s[4:7], s49 offen offset:1088 sc1 lds
    v_mfma_f32_16x16x32_bf16 v[12:15], v[164:167], v[140:143], 0
    v_mul_f32_dpp v244, v221, v236 row_newbcast:0 row_mask:0xf bank_mask:0xf
    v_mul_f32_dpp v245, v221, v237 row_newbcast:4 row_mask:0xf bank_mask:0xf
    v_cvt_pk_bf16_f32 v168, v244, v245
    v_mfma_f32_16x16x32_bf16 v[0:3], v[160:163], v[128:131], 0
    v_mul_f32_dpp v246, v221, v238 row_newbcast:8 row_mask:0xf bank_mask:0xf
    v_mul_f32_dpp v247, v221, v239 row_newbcast:12 row_mask:0xf bank_mask:0xf
    v_mfma_f32_16x16x32_bf16 v[4:7], v[160:163], v[132:135], 0
    v_cvt_pk_bf16_f32 v169, v246, v247
    v_mul_f32_dpp v244, v221, v240 row_newbcast:1 row_mask:0xf bank_mask:0xf
    v_mfma_f32_16x16x32_bf16 v[40:43], v[160:163], v[136:139], 0
    v_mul_f32_dpp v245, v221, v241 row_newbcast:5 row_mask:0xf bank_mask:0xf
    v_cvt_pk_bf16_f32 v170, v244, v245
    v_mfma_f32_16x16x32_bf16 v[44:47], v[160:163], v[140:143], 0
    v_mul_f32_dpp v246, v221, v242 row_newbcast:9 row_mask:0xf bank_mask:0xf
    v_mul_f32_dpp v247, v221, v243 row_newbcast:13 row_mask:0xf bank_mask:0xf
    v_mfma_f32_16x16x32_bf16 v[32:35], v[172:175], v[128:131], 0
    v_cvt_pk_bf16_f32 v171, v246, v247
    s_waitcnt vmcnt(7)
    ds_read_b64_tr_b16 v[146:147], v231 offset:4224
    ds_read_b64_tr_b16 v[150:151], v232 offset:4256
    ds_read_b64_tr_b16 v[154:155], v231 offset:4288
    ds_read_b64_tr_b16 v[158:159], v232 offset:4320
    v_mfma_f32_16x16x32_bf16 v[36:39], v[172:175], v[132:135], 0
    s_set_gpr_idx_on s45, gpr_idx(SRC1)
    v_mad_u32_u16 v235, 8, v199, 0
    v_lshlrev_b32 v220, 16, v198
    v_and_b32 v221, s100, v198
    v_and_b32 v222, s100, v199
    s_set_gpr_idx_off
    s_add_u32 m0, s51, 4224
    v_mfma_f32_16x16x32_bf16 v[72:75], v[172:175], v[136:139], 0
    v_xor_b32 v176, s101, v164
    s_waitcnt lgkmcnt(0)
    buffer_load_dwordx4 v224, s[4:7], s50 offen sc1 lds
    buffer_load_dwordx4 v225, s[4:7], s50 offen offset:1088 sc1 lds
    v_mfma_f32_16x16x32_bf16 v[76:79], v[172:175], v[140:143], 0
    v_xor_b32 v177, s101, v165
    v_add_u32_dpp v248, v235, v230 quad_perm:[0,0,0,0] row_mask:0xf bank_mask:0xf
    v_add_u32_dpp v249, v235, v230 quad_perm:[1,1,1,1] row_mask:0xf bank_mask:0xf
    ds_read_b64_tr_b16 v[252:253], v248
    ds_read_b64_tr_b16 v[254:255], v249
    v_mfma_f32_16x16x32_bf16 v[24:27], v[168:171], v[128:131], 0
    v_xor_b32 v178, s101, v166
    v_xor_b32 v179, s101, v167
    v_mfma_f32_16x16x32_bf16 v[28:31], v[168:171], v[132:135], 0
    v_xor_b32 v180, s101, v172
    v_xor_b32 v181, s101, v173
    v_mfma_f32_16x16x32_bf16 v[80:83], v[168:171], v[136:139], 0
    v_xor_b32 v182, s101, v174
    v_xor_b32 v183, s101, v175
    v_mfma_f32_16x16x32_bf16 v[84:87], v[168:171], v[140:143], 0
    s_waitcnt lgkmcnt(0)
    v_lshlrev_b32 v236, 16, v252
    v_and_b32 v237, s100, v252
    v_mfma_f32_16x16x32_bf16 v[84:87], v[176:179], v[148:151], v[84:87]
    v_lshlrev_b32 v238, 16, v253
    v_and_b32 v239, s100, v253
    s_waitcnt vmcnt(7)
    ds_read_b64_tr_b16 v[128:129], v231 offset:0
    ds_read_b64_tr_b16 v[132:133], v232 offset:32
    ds_read_b64_tr_b16 v[136:137], v231 offset:64
    ds_read_b64_tr_b16 v[140:141], v232 offset:96
    v_mfma_f32_16x16x32_bf16 v[80:83], v[176:179], v[144:147], v[80:83]
    v_lshlrev_b32 v240, 16, v254
    v_and_b32 v241, s100, v254
    s_add_u32 m0, s51, 0
    v_mfma_f32_16x16x32_bf16 v[72:75], v[176:179], v[152:155], v[72:75]
    v_lshlrev_b32 v242, 16, v255
    v_and_b32 v243, s100, v255
    s_waitcnt lgkmcnt(0)
    buffer_load_dwordx4 v226, s[4:7], s50 offen sc1 lds
    buffer_load_dwordx4 v227, s[4:7], s50 offen offset:1088 sc1 lds
    v_mfma_f32_16x16x32_bf16 v[76:79], v[176:179], v[156:159], v[76:79]
    v_mul_f32_dpp v244, v220, v236 row_newbcast:0 row_mask:0xf bank_mask:0xf
    v_mul_f32_dpp v245, v220, v237 row_newbcast:4 row_mask:0xf bank_mask:0xf
    v_cvt_pk_bf16_f32 v164, v244, v245
    v_mfma_f32_16x16x32_bf16 v[48:51], v[160:163], v[144:147], 0
    s_add_u32 s45, s45, 1
    s_cmp_lt_u32 s45, s44
    s_cbranch_scc0 S2f00_w
    s_lshr_b32 s54, s45, 1
    s_set_gpr_idx_on s54, gpr_idx(SRC0)
    v_mov_b32 v223, v188
    s_set_gpr_idx_off
    v_mul_f32_dpp v246, v220, v238 row_newbcast:8 row_mask:0xf bank_mask:0xf
    v_mov_b32_dpp v223, v223 row_shl:4 row_mask:0xf bank_mask:0x5
S2f00_b:
    v_mfma_f32_16x16x32_bf16 v[52:55], v[160:163], v[148:151], 0
    v_mul_f32_dpp v247, v220, v239 row_newbcast:12 row_mask:0xf bank_mask:0xf
    v_mfma_f32_16x16x32_bf16 v[56:59], v[160:163], v[152:155], 0
    v_cvt_pk_bf16_f32 v165, v246, v247
    v_add_u32_dpp v224, v223, v228 quad_perm:[0,0,0,0] row_mask:0xf bank_mask:0xf
    v_mfma_f32_16x16x32_bf16 v[60:63], v[160:163], v[156:159], 0
    v_add_u32_dpp v225, v223, v229 quad_perm:[1,1,1,1] row_mask:0xf bank_mask:0xf
    v_mul_f32_dpp v244, v220, v240 row_newbcast:1 row_mask:0xf bank_mask:0xf
    v_mfma_f32_16x16x32_bf16 v[8:11], v[168:171], v[144:147], v[8:11]
    v_mul_f32_dpp v245, v220, v241 row_newbcast:5 row_mask:0xf bank_mask:0xf
    v_cvt_pk_bf16_f32 v166, v244, v245
    s_waitcnt vmcnt(4)
    ds_read_b64_tr_b16 v[130:131], v231 offset:2112
    ds_read_b64_tr_b16 v[134:135], v232 offset:2144
    ds_read_b64_tr_b16 v[138:139], v231 offset:2176
    ds_read_b64_tr_b16 v[142:143], v232 offset:2208
    v_mfma_f32_16x16x32_bf16 v[8:11], v[172:175], v[152:155], v[8:11]
    v_mul_f32_dpp v246, v220, v242 row_newbcast:9 row_mask:0xf bank_mask:0xf
    v_mul_f32_dpp v247, v220, v243 row_newbcast:13 row_mask:0xf bank_mask:0xf
    s_add_u32 m0, s51, 2112
    v_mfma_f32_16x16x32_bf16 v[12:15], v[168:171], v[148:151], v[12:15]
    v_cvt_pk_bf16_f32 v167, v246, v247
    v_add_u32_dpp v226, v223, v228 quad_perm:[2,2,2,2] row_mask:0xf bank_mask:0xf
    s_waitcnt lgkmcnt(0)
    buffer_load_dwordx4 v224, s[4:7], s49 offen sc1 lds
    buffer_load_dwordx4 v225, s[4:7], s49 offen offset:1088 sc1 lds
    v_mfma_f32_16x16x32_bf16 v[12:15], v[172:175], v[156:159], v[12:15]
    v_add_u32_dpp v227, v223, v229 quad_perm:[3,3,3,3] row_mask:0xf bank_mask:0xf
    v_mfma_f32_16x16x32_bf16 v[64:67], v[180:183], v[144:147], 0
    v_mov_b32 v160, v252
    v_mov_b32 v161, v253
    v_mov_b32 v162, v254
    v_mov_b32 v163, v255
    v_mfma_f32_16x16x32_bf16 v[64:67], v[168:171], v[152:155], v[64:67]
    v_mul_f32_dpp v244, v222, v236 row_newbcast:0 row_mask:0xf bank_mask:0xf
    v_mul_f32_dpp v245, v222, v237 row_newbcast:4 row_mask:0xf bank_mask:0xf
    v_mfma_f32_16x16x32_bf16 v[68:71], v[180:183], v[148:151], 0
    v_cvt_pk_bf16_f32 v172, v244, v245
    v_mul_f32_dpp v246, v222, v238 row_newbcast:8 row_mask:0xf bank_mask:0xf
    v_mfma_f32_16x16x32_bf16 v[68:71], v[168:171], v[156:159], v[68:71]
    v_mul_f32_dpp v247, v222, v239 row_newbcast:12 row_mask:0xf bank_mask:0xf
    v_cvt_pk_bf16_f32 v173, v246, v247
    s_sub_u32 s46, s46, 1
    s_cbranch_scc0 S2f00_c
    s_branch EP00
S2n00:
    v_mfma_f32_16x16x32_bf16 v[16:19], v[164:167], v[128:131], v[16:19]
    v_mul_f32_dpp v244, v222, v240 row_newbcast:1 row_mask:0xf bank_mask:0xf
    v_mul_f32_dpp v245, v222, v241 row_newbcast:5 row_mask:0xf bank_mask:0xf
    s_waitcnt vmcnt(4)
    ds_read_b64_tr_b16 v[144:145], v231 offset:2112
    ds_read_b64_tr_b16 v[148:149], v232 offset:2144
    ds_read_b64_tr_b16 v[152:153], v231 offset:2176
    ds_read_b64_tr_b16 v[156:157], v232 offset:2208
    v_mfma_f32_16x16x32_bf16 v[20:23], v[164:167], v[132:135], v[20:23]
    v_cvt_pk_bf16_f32 v174, v244, v245
    v_mul_f32_dpp v246, v222, v242 row_newbcast:9 row_mask:0xf bank_mask:0xf
    s_add_u32 m0, s51, 2112
    v_mfma_f32_16x16x32_bf16 v[8:11], v[164:167], v[136:139], v[8:11]
    v_mul_f32_dpp v247, v222, v243 row_newbcast:13 row_mask:0xf bank_mask:0xf
    v_cvt_pk_bf16_f32 v175, v246, v247
    s_waitcnt lgkmcnt(0)
    buffer_load_dwordx4 v226, s[4:7], s49 offen sc1 lds
    buffer_load_dwordx4 v227, s[4:7], s49 offen offset:1088 sc1 lds
    v_mfma_f32_16x16x32_bf16 v[12:15], v[164:167], v[140:143], v[12:15]
    v_mul_f32_dpp v244, v221, v236 row_newbcast:0 row_mask:0xf bank_mask:0xf
    v_mul_f32_dpp v245, v221, v237 row_newbcast:4 row_mask:0xf bank_mask:0xf
    v_cvt_pk_bf16_f32 v168, v244, v245
    v_mfma_f32_16x16x32_bf16 v[0:3], v[160:163], v[128:131], v[0:3]
    v_mul_f32_dpp v246, v221, v238 row_newbcast:8 row_mask:0xf bank_mask:0xf
    v_mul_f32_dpp v247, v221, v239 row_newbcast:12 row_mask:0xf bank_mask:0xf
    v_mfma_f32_16x16x32_bf16 v[4:7], v[160:163], v[132:135], v[4:7]
    v_cvt_pk_bf16_f32 v169, v246, v247
    v_mul_f32_dpp v244, v221, v240 row_newbcast:1 row_mask:0xf bank_mask:0xf
    v_mfma_f32_16x16x32_bf16 v[40:43], v[160:163], v[136:139], v[40:43]
    v_mul_f32_dpp v245, v221, v241 row_newbcast:5 row_mask:0xf bank_mask:0xf
    v_cvt_pk_bf16_f32 v170, v244, v245
    v_mfma_f32_16x16x32_bf16 v[44:47], v[160:163], v[140:143], v[44:47]
    v_mul_f32_dpp v246, v221, v242 row_newbcast:9 row_mask:0xf bank_mask:0xf
    v_mul_f32_dpp v247, v221, v243 row_newbcast:13 row_mask:0xf bank_mask:0xf
    v_mfma_f32_16x16x32_bf16 v[32:35], v[172:175], v[128:131], v[32:35]
    v_cvt_pk_bf16_f32 v171, v246, v247
    s_waitcnt vmcnt(4)
    ds_read_b64_tr_b16 v[146:147], v231 offset:4224
    ds_read_b64_tr_b16 v[150:151], v232 offset:4256
    ds_read_b64_tr_b16 v[154:155], v231 offset:4288
    ds_read_b64_tr_b16 v[158:159], v232 offset:4320
    v_mfma_f32_16x16x32_bf16 v[36:39], v[172:175], v[132:135], v[36:39]
    s_set_gpr_idx_on s45, gpr_idx(SRC1)
    v_mad_u32_u16 v235, 8, v199, 0
    v_lshlrev_b32 v220, 16, v198
    v_and_b32 v221, s100, v198
    v_and_b32 v222, s100, v199
    s_set_gpr_idx_off
    s_add_u32 m0, s51, 4224
    v_mfma_f32_16x16x32_bf16 v[72:75], v[172:175], v[136:139], v[72:75]
    v_xor_b32 v176, s101, v164
    s_waitcnt lgkmcnt(0)
    buffer_load_dwordx4 v224, s[4:7], s50 offen sc1 lds
    buffer_load_dwordx4 v225, s[4:7], s50 offen offset:1088 sc1 lds
    v_mfma_f32_16x16x32_bf16 v[76:79], v[172:175], v[140:143], v[76:79]
    v_xor_b32 v177, s101, v165
    v_add_u32_dpp v248, v235, v230 quad_perm:[0,0,0,0] row_mask:0xf bank_mask:0xf
    v_add_u32_dpp v249, v235, v230 quad_perm:[1,1,1,1] row_mask:0xf bank_mask:0xf
    ds_read_b64_tr_b16 v[252:253], v248
    ds_read_b64_tr_b16 v[254:255], v249
    v_mfma_f32_16x16x32_bf16 v[24:27], v[168:171], v[128:131], v[24:27]
    v_xor_b32 v178, s101, v166
    v_xor_b32 v179, s101, v167
    v_mfma_f32_16x16x32_bf16 v[28:31], v[168:171], v[132:135], v[28:31]
    v_xor_b32 v180, s101, v172
    v_xor_b32 v181, s101, v173
    v_mfma_f32_16x16x32_bf16 v[80:83], v[168:171], v[136:139], v[80:83]
    v_xor_b32 v182, s101, v174
    v_xor_b32 v183, s101, v175
    v_mfma_f32_16x16x32_bf16 v[84:87], v[168:171], v[140:143], v[84:87]
    s_waitcnt lgkmcnt(0)
    v_lshlrev_b32 v236, 16, v252
    v_and_b32 v237, s100, v252
    v_mfma_f32_16x16x32_bf16 v[84:87], v[176:179], v[148:151], v[84:87]
    v_lshlrev_b32 v238, 16, v253
    v_and_b32 v239, s100, v253
    s_waitcnt vmcnt(4)
    ds_read_b64_tr_b16 v[128:129], v231 offset:0
    ds_read_b64_tr_b16 v[132:133], v232 offset:32
    ds_read_b64_tr_b16 v[136:137], v231 offset:64
    ds_read_b64_tr_b16 v[140:141], v232 offset:96
    v_mfma_f32_16x16x32_bf16 v[80:83], v[176:179], v[144:147], v[80:83]
    v_lshlrev_b32 v240, 16, v254
    v_and_b32 v241, s100, v254
    s_add_u32 m0, s51, 0
    v_mfma_f32_16x16x32_bf16 v[72:75], v[176:179], v[152:155], v[72:75]
    v_lshlrev_b32 v242, 16, v255
    v_and_b32 v243, s100, v255
    s_waitcnt lgkmcnt(0)
    buffer_load_dwordx4 v226, s[4:7], s50 offen sc1 lds
    buffer_load_dwordx4 v227, s[4:7], s50 offen offset:1088 sc1 lds
    v_mfma_f32_16x16x32_bf16 v[76:79], v[176:179], v[156:159], v[76:79]
    v_mul_f32_dpp v244, v220, v236 row_newbcast:0 row_mask:0xf bank_mask:0xf
    v_mul_f32_dpp v245, v220, v237 row_newbcast:4 row_mask:0xf bank_mask:0xf
    v_cvt_pk_bf16_f32 v164, v244, v245
    v_mfma_f32_16x16x32_bf16 v[48:51], v[160:163], v[144:147], v[48:51]
    s_add_u32 s45, s45, 1
    s_cmp_lt_u32 s45, s44
    s_cbranch_scc0 S2n00_w
    s_lshr_b32 s54, s45, 1
    s_set_gpr_idx_on s54, gpr_idx(SRC0)
    v_mov_b32 v223, v188
    s_set_gpr_idx_off
    v_mul_f32_dpp v246, v220, v238 row_newbcast:8 row_mask:0xf bank_mask:0xf
    v_mov_b32_dpp v223, v223 row_shl:4 row_mask:0xf bank_mask:0x5
S2n00_b:
    v_mfma_f32_16x16x32_bf16 v[52:55], v[160:163], v[148:151], v[52:55]
    v_mul_f32_dpp v247, v220, v239 row_newbcast:12 row_mask:0xf bank_mask:0xf
    v_mfma_f32_16x16x32_bf16 v[56:59], v[160:163], v[152:155], v[56:59]
    v_cvt_pk_bf16_f32 v165, v246, v247
    v_add_u32_dpp v224, v223, v228 quad_perm:[0,0,0,0] row_mask:0xf bank_mask:0xf
    v_mfma_f32_16x16x32_bf16 v[60:63], v[160:163], v[156:159], v[60:63]
    v_add_u32_dpp v225, v223, v229 quad_perm:[1,1,1,1] row_mask:0xf bank_mask:0xf
    v_mul_f32_dpp v244, v220, v240 row_newbcast:1 row_mask:0xf bank_mask:0xf
    v_mfma_f32_16x16x32_bf16 v[8:11], v[168:171], v[144:147], v[8:11]
    v_mul_f32_dpp v245, v220, v241 row_newbcast:5 row_mask:0xf bank_mask:0xf
    v_cvt_pk_bf16_f32 v166, v244, v245
    s_waitcnt vmcnt(4)
    ds_read_b64_tr_b16 v[130:131], v231 offset:2112
    ds_read_b64_tr_b16 v[134:135], v232 offset:2144
    ds_read_b64_tr_b16 v[138:139], v231 offset:2176
    ds_read_b64_tr_b16 v[142:143], v232 offset:2208
    v_mfma_f32_16x16x32_bf16 v[8:11], v[172:175], v[152:155], v[8:11]
    v_mul_f32_dpp v246, v220, v242 row_newbcast:9 row_mask:0xf bank_mask:0xf
    v_mul_f32_dpp v247, v220, v243 row_newbcast:13 row_mask:0xf bank_mask:0xf
    s_add_u32 m0, s51, 2112
    v_mfma_f32_16x16x32_bf16 v[12:15], v[168:171], v[148:151], v[12:15]
    v_cvt_pk_bf16_f32 v167, v246, v247
    v_add_u32_dpp v226, v223, v228 quad_perm:[2,2,2,2] row_mask:0xf bank_mask:0xf
    s_waitcnt lgkmcnt(0)
    buffer_load_dwordx4 v224, s[4:7], s49 offen sc1 lds
    buffer_load_dwordx4 v225, s[4:7], s49 offen offset:1088 sc1 lds
    v_mfma_f32_16x16x32_bf16 v[12:15], v[172:175], v[156:159], v[12:15]
    v_add_u32_dpp v227, v223, v229 quad_perm:[3,3,3,3] row_mask:0xf bank_mask:0xf
    v_mfma_f32_16x16x32_bf16 v[64:67], v[180:183], v[144:147], v[64:67]
    v_mov_b32 v160, v252
    v_mov_b32 v161, v253
    v_mov_b32 v162, v254
    v_mov_b32 v163, v255
    v_mfma_f32_16x16x32_bf16 v[64:67], v[168:171], v[152:155], v[64:67]
    v_mul_f32_dpp v244, v222, v236 row_newbcast:0 row_mask:0xf bank_mask:0xf
    v_mul_f32_dpp v245, v222, v237 row_newbcast:4 row_mask:0xf bank_mask:0xf
    v_mfma_f32_16x16x32_bf16 v[68:71], v[180:183], v[148:151], v[68:71]
    v_cvt_pk_bf16_f32 v172, v244, v245
    v_mul_f32_dpp v246, v222, v238 row_newbcast:8 row_mask:0xf bank_mask:0xf
    v_mfma_f32_16x16x32_bf16 v[68:71], v[168:171], v[156:159], v[68:71]
    v_mul_f32_dpp v247, v222, v239 row_newbcast:12 row_mask:0xf bank_mask:0xf
    v_cvt_pk_bf16_f32 v173, v246, v247
    s_sub_u32 s46, s46, 1
    s_cbranch_scc0 S2n00_c
    s_branch EP00
EP00_evt:
    s_cmp_eq_u32 s56, -2
    s_cbranch_scc1 EP00_end
    s_mov_b32 s59, -2
    s_and_b32 s54, s2, 31
    s_lshl_b32 s54, s54, 3
    s_add_u32 s54, s54, s3
    s_mul_i32 s54, s54, 12544
    s_add_u32 s54, s54, 3202048
    v_lshlrev_b32 v67, 7, v251
    s_mov_b32 m0, 163392
    s_nop 0
    buffer_load_dword v67, s[4:7], s54 offen lds
    s_mov_b64 exec, -1
    s_branch EP00_go
EP00_end:
    s_cmp_lg_u32 s48, 0
    s_cbranch_scc1 TAIL
    s_mov_b32 s59, -2
    s_mov_b32 s48, 1
    s_mov_b32 s52, 38416
    s_mov_b32 s57, 10240
    v_lshlrev_b32 v67, 4, v251
    buffer_load_dwordx4 v[88:91], v67, s[24:27], s57 offen offset:0
    buffer_load_dwordx4 v[92:95], v67, s[24:27], s57 offen offset:1024
    buffer_load_dwordx4 v[96:99], v67, s[24:27], s57 offen offset:2048
    buffer_load_dwordx4 v[100:103], v67, s[24:27], s57 offen offset:3072
    s_add_u32 s57, s57, 4096
    buffer_load_dwordx4 v[104:107], v67, s[24:27], s57 offen offset:0
    buffer_load_dwordx4 v[108:111], v67, s[24:27], s57 offen offset:1024
    buffer_load_dwordx4 v[112:115], v67, s[24:27], s57 offen offset:2048
    buffer_load_dwordx4 v[116:119], v67, s[24:27], s57 offen offset:3072
    s_add_u32 s57, s57, 4096
    buffer_load_dwordx4 v[120:123], v67, s[24:27], s57 offen offset:0
    buffer_load_dwordx4 v[124:127], v67, s[24:27], s57 offen offset:1024
    s_branch EP00_go
S0f01_w:
    s_mov_b32 s45, 0
    s_add_u32 s49, s49, 3200000
    s_add_u32 s50, s50, 3200000
    s_branch S0f01_b
S1n10_w:
    s_mov_b32 s45, 0
    s_add_u32 s49, s49, 3200000
    s_add_u32 s50, s50, 3200000
    s_lshr_b32 s54, s45, 1
    s_set_gpr_idx_on s54, gpr_idx(SRC0)
    v_mov_b32 v223, v188
    s_set_gpr_idx_off
    v_mul_f32_dpp v246, v220, v238 row_newbcast:8 row_mask:0xf bank_mask:0xf
    v_mov_b32_dpp v223, v223 row_shr:4 row_mask:0xf bank_mask:0xa
    s_branch S1n10_b
S1n10_c:
    s_cmp_lg_u32 s45, 0
    s_cbranch_scc1 S2n01
    s_branch S2n00
EP20_evt:
    s_cmp_eq_u32 s56, -2
    s_cbranch_scc1 EP20_end
    s_mov_b32 s59, -2
    s_and_b32 s54, s2, 31
    s_lshl_b32 s54, s54, 3
    s_add_u32 s54, s54, s3
    s_mul_i32 s54, s54, 12544
    s_add_u32 s54, s54, 3202048
    v_lshlrev_b32 v67, 7, v251
    s_mov_b32 m0, 163392
    s_nop 0
    buffer_load_dword v67, s[4:7], s54 offen lds
    s_mov_b64 exec, -1
    s_branch EP20_go
EP20_end:
    s_cmp_lg_u32 s48, 0
    s_cbranch_scc1 TAIL
    s_mov_b32 s59, -2
    s_mov_b32 s48, 1
    s_mov_b32 s52, 38416
    s_mov_b32 s57, 10240
    v_lshlrev_b32 v67, 4, v251
    buffer_load_dwordx4 v[88:91], v67, s[24:27], s57 offen offset:0
    buffer_load_dwordx4 v[92:95], v67, s[24:27], s57 offen offset:1024
    buffer_load_dwordx4 v[96:99], v67, s[24:27], s57 offen offset:2048
    buffer_load_dwordx4 v[100:103], v67, s[24:27], s57 offen offset:3072
    s_add_u32 s57, s57, 4096
    buffer_load_dwordx4 v[104:107], v67, s[24:27], s57 offen offset:0
    buffer_load_dwordx4 v[108:111], v67, s[24:27], s57 offen offset:1024
    buffer_load_dwordx4 v[112:115], v67, s[24:27], s57 offen offset:2048
    buffer_load_dwordx4 v[116:119], v67, s[24:27], s57 offen offset:3072
    s_add_u32 s57, s57, 4096
    buffer_load_dwordx4 v[120:123], v67, s[24:27], s57 offen offset:0
    buffer_load_dwordx4 v[124:127], v67, s[24:27], s57 offen offset:1024
    s_branch EP20_go
S2f01_w:
    s_mov_b32 s45, 0
    s_add_u32 s49, s49, 3200000
    s_add_u32 s50, s50, 3200000
    s_branch S2f01_b
S0n10_w:
    s_mov_b32 s45, 0
    s_add_u32 s49, s49, 3200000
    s_add_u32 s50, s50, 3200000
    s_lshr_b32 s54, s45, 1
    s_set_gpr_idx_on s54, gpr_idx(SRC0)
    v_mov_b32 v223, v188
    s_set_gpr_idx_off
    v_mul_f32_dpp v246, v220, v238 row_newbcast:8 row_mask:0xf bank_mask:0xf
    v_mov_b32_dpp v223, v223 row_shr:4 row_mask:0xf bank_mask:0xa
    s_branch S0n10_b
S0n10_c:
    s_cmp_lg_u32 s45, 0
    s_cbranch_scc1 S1n01
    s_branch S1n00
EP10_evt:
    s_cmp_eq_u32 s56, -2
    s_cbranch_scc1 EP10_end
    s_mov_b32 s59, -2
    s_and_b32 s54, s2, 31
    s_lshl_b32 s54, s54, 3
    s_add_u32 s54, s54, s3
    s_mul_i32 s54, s54, 12544
    s_add_u32 s54, s54, 3202048
    v_lshlrev_b32 v67, 7, v251
    s_mov_b32 m0, 163392
    s_nop 0
    buffer_load_dword v67, s[4:7], s54 offen lds
    s_mov_b64 exec, -1
    s_branch EP10_go
EP10_end:
    s_cmp_lg_u32 s48, 0
    s_cbranch_scc1 TAIL
    s_mov_b32 s59, -2
    s_mov_b32 s48, 1
    s_mov_b32 s52, 38416
    s_mov_b32 s57, 10240
    v_lshlrev_b32 v67, 4, v251
    buffer_load_dwordx4 v[88:91], v67, s[24:27], s57 offen offset:0
    buffer_load_dwordx4 v[92:95], v67, s[24:27], s57 offen offset:1024
    buffer_load_dwordx4 v[96:99], v67, s[24:27], s57 offen offset:2048
    buffer_load_dwordx4 v[100:103], v67, s[24:27], s57 offen offset:3072
    s_add_u32 s57, s57, 4096
    buffer_load_dwordx4 v[104:107], v67, s[24:27], s57 offen offset:0
    buffer_load_dwordx4 v[108:111], v67, s[24:27], s57 offen offset:1024
    buffer_load_dwordx4 v[112:115], v67, s[24:27], s57 offen offset:2048
    buffer_load_dwordx4 v[116:119], v67, s[24:27], s57 offen offset:3072
    s_add_u32 s57, s57, 4096
    buffer_load_dwordx4 v[120:123], v67, s[24:27], s57 offen offset:0
    buffer_load_dwordx4 v[124:127], v67, s[24:27], s57 offen offset:1024
    s_branch EP10_go
S1f01_w:
    s_mov_b32 s45, 0
    s_add_u32 s49, s49, 3200000
    s_add_u32 s50, s50, 3200000
    s_branch S1f01_b
S2n10_w:
    s_mov_b32 s45, 0
    s_add_u32 s49, s49, 3200000
    s_add_u32 s50, s50, 3200000
    s_lshr_b32 s54, s45, 1
    s_set_gpr_idx_on s54, gpr_idx(SRC0)
    v_mov_b32 v223, v188
    s_set_gpr_idx_off
    v_mul_f32_dpp v246, v220, v238 row_newbcast:8 row_mask:0xf bank_mask:0xf
    v_mov_b32_dpp v223, v223 row_shr:4 row_mask:0xf bank_mask:0xa
    s_branch S2n10_b
S2n10_c:
    s_cmp_lg_u32 s45, 0
    s_cbranch_scc1 S0n01
    s_branch S0n00
EP01_evt:
    s_cmp_eq_u32 s56, -2
    s_cbranch_scc1 EP01_end
    s_mov_b32 s59, -2
    s_and_b32 s54, s2, 31
    s_lshl_b32 s54, s54, 3
    s_add_u32 s54, s54, s3
    s_mul_i32 s54, s54, 12544
    s_add_u32 s54, s54, 3202048
    v_lshlrev_b32 v67, 7, v251
    s_mov_b32 m0, 163392
    s_nop 0
    buffer_load_dword v67, s[4:7], s54 offen lds
    s_mov_b64 exec, -1
    s_branch EP01_go
EP01_end:
    s_cmp_lg_u32 s48, 0
    s_cbranch_scc1 TAIL
    s_mov_b32 s59, -2
    s_mov_b32 s48, 1
    s_mov_b32 s52, 38416
    s_mov_b32 s57, 10240
    v_lshlrev_b32 v67, 4, v251
    buffer_load_dwordx4 v[88:91], v67, s[24:27], s57 offen offset:0
    buffer_load_dwordx4 v[92:95], v67, s[24:27], s57 offen offset:1024
    buffer_load_dwordx4 v[96:99], v67, s[24:27], s57 offen offset:2048
    buffer_load_dwordx4 v[100:103], v67, s[24:27], s57 offen offset:3072
    s_add_u32 s57, s57, 4096
    buffer_load_dwordx4 v[104:107], v67, s[24:27], s57 offen offset:0
    buffer_load_dwordx4 v[108:111], v67, s[24:27], s57 offen offset:1024
    buffer_load_dwordx4 v[112:115], v67, s[24:27], s57 offen offset:2048
    buffer_load_dwordx4 v[116:119], v67, s[24:27], s57 offen offset:3072
    s_add_u32 s57, s57, 4096
    buffer_load_dwordx4 v[120:123], v67, s[24:27], s57 offen offset:0
    buffer_load_dwordx4 v[124:127], v67, s[24:27], s57 offen offset:1024
    s_branch EP01_go
S0f10_w:
    s_mov_b32 s45, 0
    s_add_u32 s49, s49, 3200000
    s_add_u32 s50, s50, 3200000
    s_lshr_b32 s54, s45, 1
    s_set_gpr_idx_on s54, gpr_idx(SRC0)
    v_mov_b32 v223, v188
    s_set_gpr_idx_off
    v_mul_f32_dpp v246, v220, v238 row_newbcast:8 row_mask:0xf bank_mask:0xf
    v_mov_b32_dpp v223, v223 row_shr:4 row_mask:0xf bank_mask:0xa
    s_branch S0f10_b
S1n01_w:
    s_mov_b32 s45, 0
    s_add_u32 s49, s49, 3200000
    s_add_u32 s50, s50, 3200000
    s_branch S1n01_b
EP21_evt:
    s_cmp_eq_u32 s56, -2
    s_cbranch_scc1 EP21_end
    s_mov_b32 s59, -2
    s_and_b32 s54, s2, 31
    s_lshl_b32 s54, s54, 3
    s_add_u32 s54, s54, s3
    s_mul_i32 s54, s54, 12544
    s_add_u32 s54, s54, 3202048
    v_lshlrev_b32 v67, 7, v251
    s_mov_b32 m0, 163392
    s_nop 0
    buffer_load_dword v67, s[4:7], s54 offen lds
    s_mov_b64 exec, -1
    s_branch EP21_go
EP21_end:
    s_cmp_lg_u32 s48, 0
    s_cbranch_scc1 TAIL
    s_mov_b32 s59, -2
    s_mov_b32 s48, 1
    s_mov_b32 s52, 38416
    s_mov_b32 s57, 10240
    v_lshlrev_b32 v67, 4, v251
    buffer_load_dwordx4 v[88:91], v67, s[24:27], s57 offen offset:0
    buffer_load_dwordx4 v[92:95], v67, s[24:27], s57 offen offset:1024
    buffer_load_dwordx4 v[96:99], v67, s[24:27], s57 offen offset:2048
    buffer_load_dwordx4 v[100:103], v67, s[24:27], s57 offen offset:3072
    s_add_u32 s57, s57, 4096
    buffer_load_dwordx4 v[104:107], v67, s[24:27], s57 offen offset:0
    buffer_load_dwordx4 v[108:111], v67, s[24:27], s57 offen offset:1024
    buffer_load_dwordx4 v[112:115], v67, s[24:27], s57 offen offset:2048
    buffer_load_dwordx4 v[116:119], v67, s[24:27], s57 offen offset:3072
    s_add_u32 s57, s57, 4096
    buffer_load_dwordx4 v[120:123], v67, s[24:27], s57 offen offset:0
    buffer_load_dwordx4 v[124:127], v67, s[24:27], s57 offen offset:1024
    s_branch EP21_go
S2f10_w:
    s_mov_b32 s45, 0
    s_add_u32 s49, s49, 3200000
    s_add_u32 s50, s50, 3200000
    s_lshr_b32 s54, s45, 1
    s_set_gpr_idx_on s54, gpr_idx(SRC0)
    v_mov_b32 v223, v188
    s_set_gpr_idx_off
    v_mul_f32_dpp v246, v220, v238 row_newbcast:8 row_mask:0xf bank_mask:0xf
    v_mov_b32_dpp v223, v223 row_shr:4 row_mask:0xf bank_mask:0xa
    s_branch S2f10_b
S0n01_w:
    s_mov_b32 s45, 0
    s_add_u32 s49, s49, 3200000
    s_add_u32 s50, s50, 3200000
    s_branch S0n01_b
EP11_evt:
    s_cmp_eq_u32 s56, -2
    s_cbranch_scc1 EP11_end
    s_mov_b32 s59, -2
    s_and_b32 s54, s2, 31
    s_lshl_b32 s54, s54, 3
    s_add_u32 s54, s54, s3
    s_mul_i32 s54, s54, 12544
    s_add_u32 s54, s54, 3202048
    v_lshlrev_b32 v67, 7, v251
    s_mov_b32 m0, 163392
    s_nop 0
    buffer_load_dword v67, s[4:7], s54 offen lds
    s_mov_b64 exec, -1
    s_branch EP11_go
EP11_end:
    s_cmp_lg_u32 s48, 0
    s_cbranch_scc1 TAIL
    s_mov_b32 s59, -2
    s_mov_b32 s48, 1
    s_mov_b32 s52, 38416
    s_mov_b32 s57, 10240
    v_lshlrev_b32 v67, 4, v251
    buffer_load_dwordx4 v[88:91], v67, s[24:27], s57 offen offset:0
    buffer_load_dwordx4 v[92:95], v67, s[24:27], s57 offen offset:1024
    buffer_load_dwordx4 v[96:99], v67, s[24:27], s57 offen offset:2048
    buffer_load_dwordx4 v[100:103], v67, s[24:27], s57 offen offset:3072
    s_add_u32 s57, s57, 4096
    buffer_load_dwordx4 v[104:107], v67, s[24:27], s57 offen offset:0
    buffer_load_dwordx4 v[108:111], v67, s[24:27], s57 offen offset:1024
    buffer_load_dwordx4 v[112:115], v67, s[24:27], s57 offen offset:2048
    buffer_load_dwordx4 v[116:119], v67, s[24:27], s57 offen offset:3072
    s_add_u32 s57, s57, 4096
    buffer_load_dwordx4 v[120:123], v67, s[24:27], s57 offen offset:0
    buffer_load_dwordx4 v[124:127], v67, s[24:27], s57 offen offset:1024
    s_branch EP11_go
S1f10_w:
    s_mov_b32 s45, 0
    s_add_u32 s49, s49, 3200000
    s_add_u32 s50, s50, 3200000
    s_lshr_b32 s54, s45, 1
    s_set_gpr_idx_on s54, gpr_idx(SRC0)
    v_mov_b32 v223, v188
    s_set_gpr_idx_off
    v_mul_f32_dpp v246, v220, v238 row_newbcast:8 row_mask:0xf bank_mask:0xf
    v_mov_b32_dpp v223, v223 row_shr:4 row_mask:0xf bank_mask:0xa
    s_branch S1f10_b
S2n01_w:
    s_mov_b32 s45, 0
    s_add_u32 s49, s49, 3200000
    s_add_u32 s50, s50, 3200000
    s_branch S2n01_b
S0f00_w:
    s_mov_b32 s45, 0
    s_add_u32 s49, s49, 3200000
    s_add_u32 s50, s50, 3200000
    s_lshr_b32 s54, s45, 1
    s_set_gpr_idx_on s54, gpr_idx(SRC0)
    v_mov_b32 v223, v188
    s_set_gpr_idx_off
    v_mul_f32_dpp v246, v220, v238 row_newbcast:8 row_mask:0xf bank_mask:0xf
    v_mov_b32_dpp v223, v223 row_shr:4 row_mask:0xf bank_mask:0xa
    s_branch S0f00_b
S0f00_c:
    s_cmp_lg_u32 s45, 0
    s_cbranch_scc1 S1n01
    s_branch S1n00
S0n00_w:
    s_mov_b32 s45, 0
    s_add_u32 s49, s49, 3200000
    s_add_u32 s50, s50, 3200000
    s_lshr_b32 s54, s45, 1
    s_set_gpr_idx_on s54, gpr_idx(SRC0)
    v_mov_b32 v223, v188
    s_set_gpr_idx_off
    v_mul_f32_dpp v246, v220, v238 row_newbcast:8 row_mask:0xf bank_mask:0xf
    v_mov_b32_dpp v223, v223 row_shr:4 row_mask:0xf bank_mask:0xa
    s_branch S0n00_b
S0n00_c:
    s_cmp_lg_u32 s45, 0
    s_cbranch_scc1 S1n01
    s_branch S1n00
S1f00_w:
    s_mov_b32 s45, 0
    s_add_u32 s49, s49, 3200000
    s_add_u32 s50, s50, 3200000
    s_lshr_b32 s54, s45, 1
    s_set_gpr_idx_on s54, gpr_idx(SRC0)
    v_mov_b32 v223, v188
    s_set_gpr_idx_off
    v_mul_f32_dpp v246, v220, v238 row_newbcast:8 row_mask:0xf bank_mask:0xf
    v_mov_b32_dpp v223, v223 row_shr:4 row_mask:0xf bank_mask:0xa
    s_branch S1f00_b
S1f00_c:
    s_cmp_lg_u32 s45, 0
    s_cbranch_scc1 S2n01
    s_branch S2n00
S1n00_w:
    s_mov_b32 s45, 0
    s_add_u32 s49, s49, 3200000
    s_add_u32 s50, s50, 3200000
    s_lshr_b32 s54, s45, 1
    s_set_gpr_idx_on s54, gpr_idx(SRC0)
    v_mov_b32 v223, v188
    s_set_gpr_idx_off
    v_mul_f32_dpp v246, v220, v238 row_newbcast:8 row_mask:0xf bank_mask:0xf
    v_mov_b32_dpp v223, v223 row_shr:4 row_mask:0xf bank_mask:0xa
    s_branch S1n00_b
S1n00_c:
    s_cmp_lg_u32 s45, 0
    s_cbranch_scc1 S2n01
    s_branch S2n00
S2f00_w:
    s_mov_b32 s45, 0
    s_add_u32 s49, s49, 3200000
    s_add_u32 s50, s50, 3200000
    s_lshr_b32 s54, s45, 1
    s_set_gpr_idx_on s54, gpr_idx(SRC0)
    v_mov_b32 v223, v188
    s_set_gpr_idx_off
    v_mul_f32_dpp v246, v220, v238 row_newbcast:8 row_mask:0xf bank_mask:0xf
    v_mov_b32_dpp v223, v223 row_shr:4 row_mask:0xf bank_mask:0xa
    s_branch S2f00_b
S2f00_c:
    s_cmp_lg_u32 s45, 0
    s_cbranch_scc1 S0n01
    s_branch S0n00
S2n00_w:
    s_mov_b32 s45, 0
    s_add_u32 s49, s49, 3200000
    s_add_u32 s50, s50, 3200000
    s_lshr_b32 s54, s45, 1
    s_set_gpr_idx_on s54, gpr_idx(SRC0)
    v_mov_b32 v223, v188
    s_set_gpr_idx_off
    v_mul_f32_dpp v246, v220, v238 row_newbcast:8 row_mask:0xf bank_mask:0xf
    v_mov_b32_dpp v223, v223 row_shr:4 row_mask:0xf bank_mask:0xa
    s_branch S2n00_b
S2n00_c:
    s_cmp_lg_u32 s45, 0
    s_cbranch_scc1 S0n01
    s_branch S0n00
TAIL:
    s_setprio 0
    v_and_b32 v237, 15, v251
    s_lshr_b32 s56, s3, 1
    s_lshl_b32 s56, s56, 4
    v_add_u32 v237, s56, v237
    v_lshlrev_b32 v238, 2, v237
    ds_bpermute_b32 v240, v238, v218
    v_lshrrev_b32 v238, 4, v251
    v_lshlrev_b32 v238, 4, v238
    s_waitcnt lgkmcnt(0)
    v_lshl_add_u32 v240, v240, 9, v238
    v_lshlrev_b32 v236, 4, v251
    s_and_b32 s54, s3, 1
    s_mul_i32 s55, s54, 20480
    s_add_u32 s55, s55, 32768
    buffer_load_dwordx4 v[0:3], v236, s[24:27], s55 offen offset:0
    buffer_load_dwordx4 v[4:7], v236, s[24:27], s55 offen offset:1024
    buffer_load_dwordx4 v[8:11], v236, s[24:27], s55 offen offset:2048
    buffer_load_dwordx4 v[12:15], v236, s[24:27], s55 offen offset:3072
    s_add_u32 s55, s55, 4096
    buffer_load_dwordx4 v[16:19], v236, s[24:27], s55 offen offset:0
    buffer_load_dwordx4 v[20:23], v236, s[24:27], s55 offen offset:1024
    buffer_load_dwordx4 v[24:27], v236, s[24:27], s55 offen offset:2048
    buffer_load_dwordx4 v[28:31], v236, s[24:27], s55 offen offset:3072
    s_add_u32 s55, s55, 4096
    buffer_load_dwordx4 v[32:35], v236, s[24:27], s55 offen offset:0
    buffer_load_dwordx4 v[36:39], v236, s[24:27], s55 offen offset:1024
    buffer_load_dwordx4 v[40:43], v236, s[24:27], s55 offen offset:2048
    buffer_load_dwordx4 v[44:47], v236, s[24:27], s55 offen offset:3072
    s_add_u32 s55, s55, 4096
    buffer_load_dwordx4 v[48:51], v236, s[24:27], s55 offen offset:0
    buffer_load_dwordx4 v[52:55], v236, s[24:27], s55 offen offset:1024
    buffer_load_dwordx4 v[56:59], v236, s[24:27], s55 offen offset:2048
    buffer_load_dwordx4 v[60:63], v236, s[24:27], s55 offen offset:3072
    s_add_u32 s55, s55, 4096
    buffer_load_dwordx4 v[64:67], v236, s[24:27], s55 offen offset:0
    buffer_load_dwordx4 v[68:71], v236, s[24:27], s55 offen offset:1024
    buffer_load_dwordx4 v[72:75], v236, s[24:27], s55 offen offset:2048
    buffer_load_dwordx4 v[76:79], v236, s[24:27], s55 offen offset:3072
    s_waitcnt vmcnt(20)
    s_barrier
    s_lshl_b32 s55, s3, 10
    s_mov_b32 m0, s55
    s_nop 0
    buffer_load_dwordx4 v236, s[20:23], s55 offen sc1 lds
    s_add_u32 s55, s55, 8192
    s_mov_b32 m0, s55
    s_nop 0
    buffer_load_dwordx4 v236, s[20:23], s55 offen sc1 lds
    s_add_u32 s55, s55, 8192
    s_mov_b32 m0, s55
    s_nop 0
    buffer_load_dwordx4 v236, s[20:23], s55 offen sc1 lds
    s_add_u32 s55, s55, 8192
    s_mov_b32 m0, s55
    s_nop 0
    buffer_load_dwordx4 v236, s[20:23], s55 offen sc1 lds
    s_add_u32 s55, s55, 8192
    s_mov_b32 m0, s55
    s_nop 0
    buffer_load_dwordx4 v236, s[20:23], s55 offen sc1 lds
    s_add_u32 s55, s55, 8192
    s_mov_b32 m0, s55
    s_nop 0
    buffer_load_dwordx4 v236, s[20:23], s55 offen sc1 lds
    s_add_u32 s55, s55, 8192
    s_mov_b32 m0, s55
    s_nop 0
    buffer_load_dwordx4 v236, s[20:23], s55 offen sc1 lds
    s_add_u32 s55, s55, 8192
    s_mov_b32 m0, s55
    s_nop 0
    buffer_load_dwordx4 v236, s[20:23], s55 offen sc1 lds
    s_add_u32 s55, s55, 8192
    s_mov_b32 m0, s55
    s_nop 0
    buffer_load_dwordx4 v236, s[20:23], s55 offen sc1 lds
    s_add_u32 s55, s55, 8192
    s_cmp_ge_u32 s3, 4
    s_cbranch_scc1 NOP10
    s_mov_b32 m0, s55
    s_nop 0
    buffer_load_dwordx4 v236, s[20:23], s55 offen sc1 lds
    s_add_u32 s55, s55, 8192
NOP10:
    v_lshlrev_b32 v244, 1, v240
    s_lshl_b32 s57, s54, 9
    s_cmp_eq_u32 s38, 0
    s_cbranch_scc1 ZEROD
    buffer_load_dwordx4 v[188:191], v244, s[32:35], s57 offen offset:0 sc1
    buffer_load_dwordx4 v[192:195], v244, s[32:35], s57 offen offset:16 sc1
    buffer_load_dwordx4 v[196:199], v244, s[32:35], s57 offen offset:128 sc1
    buffer_load_dwordx4 v[200:203], v244, s[32:35], s57 offen offset:144 sc1
    buffer_load_dwordx4 v[204:207], v244, s[32:35], s57 offen offset:256 sc1
    buffer_load_dwordx4 v[208:211], v244, s[32:35], s57 offen offset:272 sc1
    buffer_load_dwordx4 v[212:215], v244, s[32:35], s57 offen offset:384 sc1
    buffer_load_dwordx4 v[216:219], v244, s[32:35], s57 offen offset:400 sc1
    s_branch HAVED
ZEROD:
    v_mov_b32 v188, 0
    v_mov_b32 v189, 0
    v_mov_b32 v190, 0
    v_mov_b32 v191, 0
    v_mov_b32 v192, 0
    v_mov_b32 v193, 0
    v_mov_b32 v194, 0
    v_mov_b32 v195, 0
    v_mov_b32 v196, 0
    v_mov_b32 v197, 0
    v_mov_b32 v198, 0
    v_mov_b32 v199, 0
    v_mov_b32 v200, 0
    v_mov_b32 v201, 0
    v_mov_b32 v202, 0
    v_mov_b32 v203, 0
    v_mov_b32 v204, 0
    v_mov_b32 v205, 0
    v_mov_b32 v206, 0
    v_mov_b32 v207, 0
    v_mov_b32 v208, 0
    v_mov_b32 v209, 0
    v_mov_b32 v210, 0
    v_mov_b32 v211, 0
    v_mov_b32 v212, 0
    v_mov_b32 v213, 0
    v_mov_b32 v214, 0
    v_mov_b32 v215, 0
    v_mov_b32 v216, 0
    v_mov_b32 v217, 0
    v_mov_b32 v218, 0
    v_mov_b32 v219, 0
HAVED:
    v_mul_u32_u24 v241, 784, v237
    v_add_u32 v241, v241, v238
    v_add_u32 v242, 38416, v241
    s_lshl_b32 s54, s54, 6
    s_mov_b32 s62, 0
    s_waitcnt vmcnt(0)
    s_barrier
T_MM:
    s_cmp_eq_u32 s78, 0
    s_cbranch_scc1 MORE0
    ds_read_b128 v[80:83], v241 offset:0
    ds_read_b128 v[84:87], v242 offset:0
    ds_read_b128 v[88:91], v241 offset:64
    ds_read_b128 v[92:95], v242 offset:64
    ds_read_b128 v[96:99], v241 offset:128
    ds_read_b128 v[100:103], v242 offset:128
    ds_read_b128 v[104:107], v241 offset:320
    ds_read_b128 v[108:111], v242 offset:320
    ds_read_b128 v[112:115], v241 offset:512
    ds_read_b128 v[116:119], v242 offset:512
    ds_read_b128 v[120:123], v241 offset:192
    ds_read_b128 v[124:127], v242 offset:192
    s_waitcnt lgkmcnt(11)
    v_mfma_f32_16x16x32_bf16 v[188:191], v[0:3], v[80:83], v[188:191]
    v_mfma_f32_16x16x32_bf16 v[192:195], v[40:43], v[80:83], v[192:195]
    ds_read_b128 v[128:131], v241 offset:384
    s_waitcnt lgkmcnt(11)
    v_mfma_f32_16x16x32_bf16 v[188:191], v[4:7], v[84:87], v[188:191]
    v_mfma_f32_16x16x32_bf16 v[192:195], v[44:47], v[84:87], v[192:195]
    ds_read_b128 v[132:135], v242 offset:384
    s_waitcnt lgkmcnt(11)
    v_mfma_f32_16x16x32_bf16 v[188:191], v[8:11], v[88:91], v[188:191]
    v_mfma_f32_16x16x32_bf16 v[192:195], v[48:51], v[88:91], v[192:195]
    ds_read_b128 v[136:139], v241 offset:576
    s_waitcnt lgkmcnt(11)
    v_mfma_f32_16x16x32_bf16 v[188:191], v[12:15], v[92:95], v[188:191]
    v_mfma_f32_16x16x32_bf16 v[192:195], v[52:55], v[92:95], v[192:195]
    ds_read_b128 v[140:143], v242 offset:576
    s_waitcnt lgkmcnt(11)
    v_mfma_f32_16x16x32_bf16 v[196:199], v[16:19], v[96:99], v[196:199]
    v_mfma_f32_16x16x32_bf16 v[200:203], v[56:59], v[96:99], v[200:203]
    ds_read_b128 v[144:147], v241 offset:256
    s_waitcnt lgkmcnt(11)
    v_mfma_f32_16x16x32_bf16 v[196:199], v[20:23], v[100:103], v[196:199]
    v_mfma_f32_16x16x32_bf16 v[200:203], v[60:63], v[100:103], v[200:203]
    v_cvt_pk_bf16_f32 v8, v188, v189
    v_cvt_pk_bf16_f32 v9, v190, v191
    ds_read_b128 v[148:151], v242 offset:256
    s_waitcnt lgkmcnt(11)
    v_mfma_f32_16x16x32_bf16 v[196:199], v[24:27], v[104:107], v[196:199]
    v_cvt_pk_bf16_f32 v10, v192, v193
    v_cvt_pk_bf16_f32 v11, v194, v195
    v_mfma_f32_16x16x32_bf16 v[200:203], v[64:67], v[104:107], v[200:203]
    buffer_store_dwordx4 v[8:11], v240, s[28:31], s54 offen offset:0
    v_mul_f32 v0, 0xbfb8aa3b, v188
    ds_read_b128 v[152:155], v241 offset:448
    s_waitcnt lgkmcnt(11)
    v_mfma_f32_16x16x32_bf16 v[196:199], v[28:31], v[108:111], v[196:199]
    v_mul_f32 v1, 0xbfb8aa3b, v189
    v_mul_f32 v2, 0xbfb8aa3b, v190
    v_mfma_f32_16x16x32_bf16 v[200:203], v[68:71], v[108:111], v[200:203]
    v_mul_f32 v3, 0xbfb8aa3b, v191
    v_mul_f32 v4, 0xbfb8aa3b, v192
    ds_read_b128 v[156:159], v242 offset:448
    s_waitcnt lgkmcnt(11)
    v_mfma_f32_16x16x32_bf16 v[196:199], v[32:35], v[112:115], v[196:199]
    v_mul_f32 v5, 0xbfb8aa3b, v193
    v_mul_f32 v6, 0xbfb8aa3b, v194
    v_mfma_f32_16x16x32_bf16 v[200:203], v[72:75], v[112:115], v[200:203]
    v_mul_f32 v7, 0xbfb8aa3b, v195
    v_exp_f32 v0, v0
    ds_read_b128 v[160:163], v241 offset:640
    s_waitcnt lgkmcnt(11)
    v_mfma_f32_16x16x32_bf16 v[196:199], v[36:39], v[116:119], v[196:199]
    v_exp_f32 v1, v1
    v_exp_f32 v2, v2
    v_mfma_f32_16x16x32_bf16 v[200:203], v[76:79], v[116:119], v[200:203]
    v_exp_f32 v3, v3
    v_exp_f32 v4, v4
    ds_read_b128 v[164:167], v242 offset:640
    s_waitcnt lgkmcnt(11)
    v_mfma_f32_16x16x32_bf16 v[204:207], v[16:19], v[120:123], v[204:207]
    v_exp_f32 v5, v5
    v_exp_f32 v6, v6
    v_mfma_f32_16x16x32_bf16 v[208:211], v[56:59], v[120:123], v[208:211]
    v_exp_f32 v7, v7
    v_add_f32 v0, 1.0, v0
    s_waitcnt lgkmcnt(10)
    v_mfma_f32_16x16x32_bf16 v[204:207], v[20:23], v[124:127], v[204:207]
    v_add_f32 v1, 1.0, v1
    v_add_f32 v2, 1.0, v2
    v_mfma_f32_16x16x32_bf16 v[208:211], v[60:63], v[124:127], v[208:211]
    v_add_f32 v3, 1.0, v3
    v_add_f32 v4, 1.0, v4
    s_waitcnt lgkmcnt(9)
    v_mfma_f32_16x16x32_bf16 v[204:207], v[24:27], v[128:131], v[204:207]
    v_add_f32 v5, 1.0, v5
    v_add_f32 v6, 1.0, v6
    v_mfma_f32_16x16x32_bf16 v[208:211], v[64:67], v[128:131], v[208:211]
    v_add_f32 v7, 1.0, v7
    v_rcp_f32 v0, v0
    s_waitcnt lgkmcnt(8)
    v_mfma_f32_16x16x32_bf16 v[204:207], v[28:31], v[132:135], v[204:207]
    v_rcp_f32 v1, v1
    v_rcp_f32 v2, v2
    v_mfma_f32_16x16x32_bf16 v[208:211], v[68:71], v[132:135], v[208:211]
    v_rcp_f32 v3, v3
    v_rcp_f32 v4, v4
    s_waitcnt lgkmcnt(7)
    v_mfma_f32_16x16x32_bf16 v[204:207], v[32:35], v[136:139], v[204:207]
    v_rcp_f32 v5, v5
    v_rcp_f32 v6, v6
    v_mfma_f32_16x16x32_bf16 v[208:211], v[72:75], v[136:139], v[208:211]
    v_rcp_f32 v7, v7
    v_mul_f32 v196, v196, v0
    v_mul_f32 v197, v197, v1
    s_waitcnt lgkmcnt(6)
    v_mfma_f32_16x16x32_bf16 v[204:207], v[36:39], v[140:143], v[204:207]
    v_mul_f32 v198, v198, v2
    v_mul_f32 v199, v199, v3
    v_mfma_f32_16x16x32_bf16 v[208:211], v[76:79], v[140:143], v[208:211]
    v_mul_f32 v200, v200, v4
    v_mul_f32 v201, v201, v5
    s_waitcnt lgkmcnt(5)
    v_mfma_f32_16x16x32_bf16 v[212:215], v[16:19], v[144:147], v[212:215]
    v_mul_f32 v202, v202, v6
    v_mul_f32 v203, v203, v7
    v_mfma_f32_16x16x32_bf16 v[216:219], v[56:59], v[144:147], v[216:219]
    v_cvt_pk_bf16_f32 v12, v196, v197
    v_cvt_pk_bf16_f32 v13, v198, v199
    s_waitcnt lgkmcnt(4)
    v_mfma_f32_16x16x32_bf16 v[212:215], v[20:23], v[148:151], v[212:215]
    v_cvt_pk_bf16_f32 v14, v200, v201
    v_cvt_pk_bf16_f32 v15, v202, v203
    v_mfma_f32_16x16x32_bf16 v[216:219], v[60:63], v[148:151], v[216:219]
    buffer_store_dwordx4 v[12:15], v240, s[28:31], s54 offen offset:128
    s_waitcnt lgkmcnt(3)
    v_mfma_f32_16x16x32_bf16 v[212:215], v[24:27], v[152:155], v[212:215]
    v_mul_f32 v204, v204, v0
    v_mul_f32 v205, v205, v1
    v_mfma_f32_16x16x32_bf16 v[216:219], v[64:67], v[152:155], v[216:219]
    v_mul_f32 v206, v206, v2
    v_mul_f32 v207, v207, v3
    s_waitcnt lgkmcnt(2)
    v_mfma_f32_16x16x32_bf16 v[212:215], v[28:31], v[156:159], v[212:215]
    v_mul_f32 v208, v208, v4
    v_mul_f32 v209, v209, v5
    v_mfma_f32_16x16x32_bf16 v[216:219], v[68:71], v[156:159], v[216:219]
    v_mul_f32 v210, v210, v6
    v_mul_f32 v211, v211, v7
    s_waitcnt lgkmcnt(1)
    v_mfma_f32_16x16x32_bf16 v[212:215], v[32:35], v[160:163], v[212:215]
    v_cvt_pk_bf16_f32 v40, v204, v205
    v_cvt_pk_bf16_f32 v41, v206, v207
    v_mfma_f32_16x16x32_bf16 v[216:219], v[72:75], v[160:163], v[216:219]
    v_cvt_pk_bf16_f32 v42, v208, v209
    v_cvt_pk_bf16_f32 v43, v210, v211
    s_waitcnt lgkmcnt(0)
    v_mfma_f32_16x16x32_bf16 v[212:215], v[36:39], v[164:167], v[212:215]
    buffer_store_dwordx4 v[40:43], v240, s[28:31], s54 offen offset:256
    v_mfma_f32_16x16x32_bf16 v[216:219], v[76:79], v[164:167], v[216:219]
    s_nop 5
    v_mul_f32 v212, v212, v0
    v_mul_f32 v213, v213, v1
    v_mul_f32 v214, v214, v2
    v_mul_f32 v215, v215, v3
    v_mul_f32 v216, v216, v4
    v_mul_f32 v217, v217, v5
    v_mul_f32 v218, v218, v6
    v_mul_f32 v219, v219, v7
    v_cvt_pk_bf16_f32 v44, v212, v213
    v_cvt_pk_bf16_f32 v45, v214, v215
    v_cvt_pk_bf16_f32 v46, v216, v217
    v_cvt_pk_bf16_f32 v47, v218, v219
    buffer_store_dwordx4 v[44:47], v240, s[28:31], s54 offen offset:384
    s_endpgm
MORE0:
    ds_read_b128 v[80:83], v241 offset:0
    ds_read_b128 v[84:87], v242 offset:0
    ds_read_b128 v[88:91], v241 offset:64
    ds_read_b128 v[92:95], v242 offset:64
    ds_read_b128 v[96:99], v241 offset:128
    ds_read_b128 v[100:103], v242 offset:128
    ds_read_b128 v[104:107], v241 offset:320
    ds_read_b128 v[108:111], v242 offset:320
    ds_read_b128 v[112:115], v241 offset:512
    ds_read_b128 v[116:119], v242 offset:512
    ds_read_b128 v[120:123], v241 offset:192
    ds_read_b128 v[124:127], v242 offset:192
    s_waitcnt lgkmcnt(11)
    v_mfma_f32_16x16x32_bf16 v[188:191], v[0:3], v[80:83], v[188:191]
    v_mfma_f32_16x16x32_bf16 v[192:195], v[40:43], v[80:83], v[192:195]
    ds_read_b128 v[128:131], v241 offset:384
    s_waitcnt lgkmcnt(11)
    v_mfma_f32_16x16x32_bf16 v[188:191], v[4:7], v[84:87], v[188:191]
    v_mfma_f32_16x16x32_bf16 v[192:195], v[44:47], v[84:87], v[192:195]
    ds_read_b128 v[132:135], v242 offset:384
    s_waitcnt lgkmcnt(11)
    v_mfma_f32_16x16x32_bf16 v[188:191], v[8:11], v[88:91], v[188:191]
    v_mfma_f32_16x16x32_bf16 v[192:195], v[48:51], v[88:91], v[192:195]
    ds_read_b128 v[136:139], v241 offset:576
    s_waitcnt lgkmcnt(11)
    v_mfma_f32_16x16x32_bf16 v[188:191], v[12:15], v[92:95], v[188:191]
    v_mfma_f32_16x16x32_bf16 v[192:195], v[52:55], v[92:95], v[192:195]
    ds_read_b128 v[140:143], v242 offset:576
    s_waitcnt lgkmcnt(11)
    v_mfma_f32_16x16x32_bf16 v[196:199], v[16:19], v[96:99], v[196:199]
    v_mfma_f32_16x16x32_bf16 v[200:203], v[56:59], v[96:99], v[200:203]
    ds_read_b128 v[144:147], v241 offset:256
    s_waitcnt lgkmcnt(11)
    v_mfma_f32_16x16x32_bf16 v[196:199], v[20:23], v[100:103], v[196:199]
    v_mfma_f32_16x16x32_bf16 v[200:203], v[60:63], v[100:103], v[200:203]
    ds_read_b128 v[148:151], v242 offset:256
    s_waitcnt lgkmcnt(11)
    v_mfma_f32_16x16x32_bf16 v[196:199], v[24:27], v[104:107], v[196:199]
    v_mfma_f32_16x16x32_bf16 v[200:203], v[64:67], v[104:107], v[200:203]
    ds_read_b128 v[152:155], v241 offset:448
    s_waitcnt lgkmcnt(11)
    v_mfma_f32_16x16x32_bf16 v[196:199], v[28:31], v[108:111], v[196:199]
    v_mfma_f32_16x16x32_bf16 v[200:203], v[68:71], v[108:111], v[200:203]
    ds_read_b128 v[156:159], v242 offset:448
    s_waitcnt lgkmcnt(11)
    v_mfma_f32_16x16x32_bf16 v[196:199], v[32:35], v[112:115], v[196:199]
    v_mfma_f32_16x16x32_bf16 v[200:203], v[72:75], v[112:115], v[200:203]
    ds_read_b128 v[160:163], v241 offset:640
    s_waitcnt lgkmcnt(11)
    v_mfma_f32_16x16x32_bf16 v[196:199], v[36:39], v[116:119], v[196:199]
    v_mfma_f32_16x16x32_bf16 v[200:203], v[76:79], v[116:119], v[200:203]
    ds_read_b128 v[164:167], v242 offset:640
    s_waitcnt lgkmcnt(11)
    v_mfma_f32_16x16x32_bf16 v[204:207], v[16:19], v[120:123], v[204:207]
    v_mfma_f32_16x16x32_bf16 v[208:211], v[56:59], v[120:123], v[208:211]
    s_waitcnt lgkmcnt(10)
    v_mfma_f32_16x16x32_bf16 v[204:207], v[20:23], v[124:127], v[204:207]
    v_mfma_f32_16x16x32_bf16 v[208:211], v[60:63], v[124:127], v[208:211]
    s_waitcnt lgkmcnt(9)
    v_mfma_f32_16x16x32_bf16 v[204:207], v[24:27], v[128:131], v[204:207]
    v_mfma_f32_16x16x32_bf16 v[208:211], v[64:67], v[128:131], v[208:211]
    s_waitcnt lgkmcnt(8)
    v_mfma_f32_16x16x32_bf16 v[204:207], v[28:31], v[132:135], v[204:207]
    v_mfma_f32_16x16x32_bf16 v[208:211], v[68:71], v[132:135], v[208:211]
    s_waitcnt lgkmcnt(7)
    v_mfma_f32_16x16x32_bf16 v[204:207], v[32:35], v[136:139], v[204:207]
    v_mfma_f32_16x16x32_bf16 v[208:211], v[72:75], v[136:139], v[208:211]
    s_waitcnt lgkmcnt(6)
    v_mfma_f32_16x16x32_bf16 v[204:207], v[36:39], v[140:143], v[204:207]
    v_mfma_f32_16x16x32_bf16 v[208:211], v[76:79], v[140:143], v[208:211]
    s_waitcnt lgkmcnt(5)
    v_mfma_f32_16x16x32_bf16 v[212:215], v[16:19], v[144:147], v[212:215]
    v_mfma_f32_16x16x32_bf16 v[216:219], v[56:59], v[144:147], v[216:219]
    s_waitcnt lgkmcnt(4)
    v_mfma_f32_16x16x32_bf16 v[212:215], v[20:23], v[148:151], v[212:215]
    v_mfma_f32_16x16x32_bf16 v[216:219], v[60:63], v[148:151], v[216:219]
    s_waitcnt lgkmcnt(3)
    v_mfma_f32_16x16x32_bf16 v[212:215], v[24:27], v[152:155], v[212:215]
    v_mfma_f32_16x16x32_bf16 v[216:219], v[64:67], v[152:155], v[216:219]
    s_waitcnt lgkmcnt(2)
    v_mfma_f32_16x16x32_bf16 v[212:215], v[28:31], v[156:159], v[212:215]
    v_mfma_f32_16x16x32_bf16 v[216:219], v[68:71], v[156:159], v[216:219]
    s_waitcnt lgkmcnt(1)
    v_mfma_f32_16x16x32_bf16 v[212:215], v[32:35], v[160:163], v[212:215]
    v_mfma_f32_16x16x32_bf16 v[216:219], v[72:75], v[160:163], v[216:219]
    s_waitcnt lgkmcnt(0)
    v_mfma_f32_16x16x32_bf16 v[212:215], v[36:39], v[164:167], v[212:215]
    v_mfma_f32_16x16x32_bf16 v[216:219], v[76:79], v[164:167], v[216:219]
MORE:
    buffer_store_dwordx4 v[188:191], v244, s[32:35], s57 offen offset:0
    buffer_store_dwordx4 v[192:195], v244, s[32:35], s57 offen offset:16
    buffer_store_dwordx4 v[196:199], v244, s[32:35], s57 offen offset:128
    buffer_store_dwordx4 v[200:203], v244, s[32:35], s57 offen offset:144
    buffer_store_dwordx4 v[204:207], v244, s[32:35], s57 offen offset:256
    buffer_store_dwordx4 v[208:211], v244, s[32:35], s57 offen offset:272
    s_nop 0
    buffer_store_dwordx4 v[212:215], v244, s[32:35], s57 offen offset:384
    buffer_store_dwordx4 v[216:219], v244, s[32:35], s57 offen offset:400
    s_lshl_b32 s54, s3, 6
    v_add_u32 v250, s54, v251
    s_add_u32 s38, s38, s39
    s_waitcnt vmcnt(0)
    s_barrier
    s_branch ROUND
K2_end:
    s_endpgm
.section .rodata,"a"
.p2align 6
.amdhsa_kernel gather_scatter__tensor_product_equiv_equiformer__graph_kernel
  .amdhsa_next_free_vgpr 256
  .amdhsa_next_free_sgpr 102
  .amdhsa_accum_offset 256
  .amdhsa_group_segment_fixed_size 0
  .amdhsa_kernarg_size 96
  .amdhsa_user_sgpr_count 2
  .amdhsa_user_sgpr_kernarg_segment_ptr 1
  .amdhsa_system_sgpr_workgroup_id_x 1
  .amdhsa_float_denorm_mode_32 3
.end_amdhsa_kernel
```
